```python
import torch

def _softmax(x, axis=-1):
    return torch.softmax(x, dim=axis)
def _gelu(x):
    return torch.nn.functional.gelu(x, approximate="tanh")
def _silu(x):
    return torch.nn.functional.silu(x)
def _sigmoid(x):
    return torch.sigmoid(x)
def _layernorm(x, axis=-1, eps=1e-5):
    m = x.mean(dim=axis, keepdim=True)
    v = x.var(dim=axis, keepdim=True, unbiased=False)
    return (x - m) / torch.sqrt(v + eps)
def _scatter_add(tgt, idx, src, axis=0):
    return tgt.clone().index_add_(axis, idx, src)
def _segment_sum(src, seg, n):
    out = torch.zeros((n,) + src.shape[1:], dtype=src.dtype)
    return out.index_add_(0, seg, src)
def _pad(x, pw):
    flat = tuple(v for pair in reversed(pw) for v in pair)
    return torch.nn.functional.pad(x, flat)

kernel_name = 'sequential_preLN__ssm_conv_h3__glu_gated_swiglu__prompt'

def setup_inputs():

    _w = (lambda a: (lambda t: t.to(torch.bfloat16) if t.is_floating_point() else t)(torch.as_tensor(a)))
    def _A_setup():
        B, S, D = 1, 2048, 448
        ks = 4
        return {
            "q": _w((lambda *s: torch.randn(*s, dtype=torch.bfloat16) * 0.05)(B, S, D)),
            "k": _w((lambda *s: torch.randn(*s, dtype=torch.bfloat16) * 0.2)(B, S, D)),
            "v": _w((lambda *s: torch.randn(*s, dtype=torch.bfloat16) * 0.2)(B, S, D)),
            "shift_k": _w((lambda *s: torch.randn(*s, dtype=torch.bfloat16) * 0.2)(D, ks) * 0.5),
            "ssm_k": _w((lambda *s: torch.randn(*s, dtype=torch.bfloat16) * 0.4)(D, S) * (1.0 / S ** 0.5)),
            "ssm_D": _w((lambda *s: torch.randn(*s, dtype=torch.bfloat16) * 0.2)(D)),
        }
    _A_in = _A_setup()

    def _B_setup():
        B, S, D, F = 1, 2048, 448, 1792
        return {
            "x": _w((lambda *s: torch.randn(*s, dtype=torch.bfloat16) * 0.05)(B, S, D)),
            "w1": _w((lambda *s: torch.randn(*s, dtype=torch.bfloat16) * 0.2)(D, F) * (2.0 / D) ** 0.5),
            "w3": _w((lambda *s: torch.randn(*s, dtype=torch.bfloat16) * 0.2)(D, F) * (2.0 / D) ** 0.5),
            "w2": _w((lambda *s: torch.randn(*s, dtype=torch.bfloat16) * 0.2)(F, D) * (2.0 / F) ** 0.5),
        }
    _B_in = _B_setup()

    return {
        "A_q": _A_in["q"],
        "A_k": _A_in["k"],
        "A_v": _A_in["v"],
        "A_shift_k": _A_in["shift_k"],
        "A_ssm_k": _A_in["ssm_k"],
        "A_ssm_D": _A_in["ssm_D"],
        "B_x": _B_in["x"],
        "B_w1": _B_in["w1"],
        "B_w3": _B_in["w3"],
        "B_w2": _B_in["w2"],
    }

def reference(A_q, A_k, A_v, A_shift_k, A_ssm_k, A_ssm_D, B_x, B_w1, B_w3, B_w2):
    def _A_ref(q, k, v, shift_k, ssm_k, ssm_D):
        B, S, D = q.shape
        ks = shift_k.shape[-1]
        k_pad = _pad(k, ((0, 0), (ks - 1, 0), (0, 0)))
        k_shift = torch.zeros_like(k)
        for t in range(ks):
            k_shift = k_shift + k_pad[:, t:t + S, :] * shift_k[:, ks - 1 - t][None, None, :]
        kv = k_shift * v
        L = 2 * S
        kv_pad = _pad(kv, ((0, 0), (0, S), (0, 0)))
        kf_pad = _pad(ssm_k, ((0, 0), (0, S)))
        kv_f = (lambda x, axes=(-2,-1): torch.fft.rfft2(x.float(), dim=axes))(kv_pad[:, None, :, :], axes=(1, 2))
        kf_f = (lambda x, axes=(-2,-1): torch.fft.rfft2(x.float(), dim=axes))(kf_pad[:, None, :], axes=(1, 2))
        kf_f = (lambda x, *d: x.permute(*d))(kf_f, 1, 2, 0)
        y_f = kv_f * kf_f[None, :, :, :]
        y = (lambda x, s, axes=(-2,-1): torch.fft.irfft2(x, s=s, dim=axes).to(torch.bfloat16))(y_f, (1, L), axes=(1, 2))[:, 0, :S, :]
        y = y + kv * ssm_D[None, None, :]
        return q * y

    def _B_ref(x, w1, w3, w2):
        gate = torch.einsum("bsd,df->bsf", x, w1)
        up = torch.einsum("bsd,df->bsf", x, w3)
        h = _silu(gate) * up
        out = torch.einsum("bsf,fd->bsd", h, w2)
        return out

    x = A_q
    h = x + _A_ref(_layernorm(x, axis=-1), A_k, A_v, A_shift_k, A_ssm_k, A_ssm_D)
    h2 = h + _B_ref(_layernorm(h, axis=-1), B_w1, B_w3, B_w2)
    return h2
```

```asm
; @launch kernel=pc_kernel grid=(256,1,1) block=(256,1,1) lds=163840
.amdgcn_target "amdgcn-amd-amdhsa--gfx950"
.text
.globl pc_kernel
.p2align 12
.p2align 8
.type pc_kernel,@function
pc_kernel:
    s_cmp_ge_u32 s2, 256
    s_cbranch_scc1 L_pc_end
    s_load_dwordx2 s[56:57], s[0:1], 8
    s_load_dwordx2 s[60:61], s[0:1], 16
    s_load_dwordx2 s[68:69], s[0:1], 24
    s_load_dwordx2 s[64:65], s[0:1], 0
    s_load_dwordx2 s[32:33], s[0:1], 88
    s_load_dwordx2 s[12:13], s[0:1], 96
    s_memrealtime s[36:37]
    v_lshrrev_b32 v2, 6, v0
    v_and_b32 v1, 63, v0
    v_readfirstlane_b32 s16, v2
    s_and_b32 s80, s2, 7
    s_lshr_b32 s81, s2, 3
    s_mov_b32 s34, 4
    s_mov_b32 s35, 0x00020000
    s_mov_b32 s100, 40000
    s_cmp_lt_u32 s2, 224
    s_cbranch_scc1 L_pc_main
    s_mov_b64 exec, 0
    s_cmp_eq_u32 s16, 1
    s_cbranch_scc1 L_ts0
    s_cmp_eq_u32 s16, 2
    s_cbranch_scc1 L_ts1
    s_cmp_eq_u32 s16, 3
    s_cbranch_scc1 L_ts2
    s_mov_b64 exec, -1
    s_xor_b32 s15, s2, 224
    s_or_b32 s15, s15, s16
    s_cbranch_scc1 L_pc_spare
    v_lshlrev_b32 v9, 24, v1
    s_waitcnt lgkmcnt(0)
    s_or_b32 s36, s36, 1
    v_mov_b32 v14, s36
    buffer_store_dword v14, v9, s[32:35], 0 offen sc1
    s_branch L_pc_spare
L_pc_main:
    s_load_dwordx4 s[4:7], s[0:1], 32
    s_load_dwordx2 s[8:9], s[0:1], 72
    s_load_dwordx4 s[76:79], s[0:1], 56
    s_and_b32 s83, s81, 3
    s_lshl_b32 s82, s80, 2
    s_add_u32 s83, s83, s82
    s_lshr_b32 s82, s81, 2
    s_and_b32 s15, s16, 3
    s_lshl_b32 s14, s82, 2
    s_add_u32 s101, s14, s15
    v_and_b32 v96, 7, v1
    v_and_b32 v97, 56, v1
    s_lshl_b32 s14, s83, 6
    v_add_u32 v97, s14, v97
    s_lshl_b32 s14, s101, 4
    v_lshl_add_u32 v96, v96, 1, s14
    v_mul_u32_u24 v98, 896, v97
    v_lshl_add_u32 v98, v96, 1, v98
    v_add_u32 v99, 3584, v98
    v_subrev_u32 v100, 2688, v98
    v_lshlrev_b32 v101, 3, v96
    s_mov_b32 s58, 0x1c0000
    s_mov_b32 s59, 0x00020000
    s_mov_b32 s62, 0x1c0000
    s_mov_b32 s63, 0x00020000
    s_mov_b32 s66, 0x1c0000
    s_mov_b32 s67, 0x00020000
    s_mov_b32 s70, 3584
    s_mov_b32 s71, 0x00020000
    s_lshl_b32 s40, s82, 5
    s_add_u32 s40, s40, s83
    s_bfe_u32 s17, s16, 0x10001
    s_and_b32 s18, s16, 1
    s_lshl_b32 s19, s40, 1
    s_add_u32 s19, s19, s17
    s_lshl_b32 s19, s19, 12
    s_lshl_b32 s38, s18, 11
    v_lshl_add_u32 v5, v1, 4, s38
    s_waitcnt lgkmcnt(0)
    buffer_load_dword v16, v100, s[56:59], 0 offen offset:0
    buffer_load_dword v17, v100, s[56:59], 0 offen offset:896
    buffer_load_dword v18, v100, s[56:59], 0 offen offset:1792
    buffer_load_dword v19, v98, s[56:59], 0 offen offset:0
    buffer_load_dword v20, v98, s[56:59], 0 offen offset:896
    buffer_load_dword v21, v98, s[56:59], 0 offen offset:1792
    buffer_load_dword v22, v98, s[56:59], 0 offen offset:2688
    buffer_load_dword v23, v99, s[56:59], 0 offen offset:0
    buffer_load_dword v24, v99, s[56:59], 0 offen offset:896
    buffer_load_dword v25, v99, s[56:59], 0 offen offset:1792
    buffer_load_dword v26, v99, s[56:59], 0 offen offset:2688
    buffer_load_dwordx4 v[36:39], v101, s[68:71], 0 offen
    buffer_load_dword v27, v98, s[60:63], 0 offen offset:0
    buffer_load_dword v28, v98, s[60:63], 0 offen offset:896
    buffer_load_dword v29, v98, s[60:63], 0 offen offset:1792
    buffer_load_dword v30, v98, s[60:63], 0 offen offset:2688
    buffer_load_dword v31, v99, s[60:63], 0 offen offset:0
    buffer_load_dword v32, v99, s[60:63], 0 offen offset:896
    buffer_load_dword v33, v99, s[60:63], 0 offen offset:1792
    buffer_load_dword v34, v99, s[60:63], 0 offen offset:2688
    v_subrev_u32 v6, 16, v5
    s_mov_b32 s22, 4096
    s_mov_b32 s23, 0x00020000
    s_add_u32 s20, s4, s19
    s_addc_u32 s21, s5, 0
    s_lshl_b32 s14, s40, 2
    s_load_dword s41, s[6:7], s14
    s_lshl_b32 s14, s80, 5
    s_add_u32 s14, s14, s81
    s_lshl_b32 s38, s14, 2
    s_add_u32 s38, s38, s16
    s_mul_i32 s38, s38, 1792
    v_lshl_add_u32 v176, v1, 4, s38
    v_cmp_gt_u32 vcc, 56, v1
    v_mov_b32 v177, 0x80000000
    s_nop 0
    v_cndmask_b32 v176, v177, v176, vcc
    v_sub_u32 v177, 63, v1
    s_lshr_b32 s38, s14, 6
    s_lshl_b32 s38, s38, 2
    s_add_u32 s38, s38, s16
    s_lshl_b32 s38, s38, 6
    s_and_b32 s14, s14, 63
    s_add_u32 s14, s14, s38
    s_lshl_b32 s14, s14, 4
    v_lshl_add_u32 v177, v177, 24, s14
    s_mul_i32 s82, s2, 9363
    s_lshr_b32 s82, s82, 16
    s_mul_i32 s14, s82, 7
    s_sub_u32 s14, s2, s14
    s_lshl_b32 s14, s14, 2
    s_cmp_eq_u32 s16, 1
    s_cselect_b32 s15, 0, s16
    s_cselect_b32 s47, 28672, s71
    s_add_u32 s75, s14, s15
    s_and_b32 s15, s75, 1
    s_lshl_b32 s14, s75, 1
    s_sub_u32 s14, s14, s15
    s_mul_i32 s14, s14, 28672
    s_lshl_b32 s15, s82, 7
    s_add_u32 s14, s14, s15
    s_add_u32 s56, s76, s14
    s_addc_u32 s57, s77, 0
    s_add_u32 s60, s78, s14
    s_addc_u32 s61, s79, 0
    s_cmp_eq_u32 s16, 0
    s_cselect_b32 s58, 0, 111232
    s_cmp_ge_u32 s2, 196
    s_cselect_b32 s58, 0, s58
    s_mov_b32 s62, s58
    v_lshrrev_b32 v240, 3, v1
    v_and_b32 v241, 7, v1
    v_mul_u32_u24 v240, 3584, v240
    v_lshl_add_u32 v240, v241, 4, v240
    v_add_u32 v241, 57344, v240
    v_mov_b32 v248, -16
    v_and_b32 v3, 15, v1
    v_lshrrev_b32 v4, 4, v1
    s_lshl_b32 s4, s101, 5
    s_add_u32 s4, s4, s83
    s_mul_i32 s4, s4, 4
    s_add_u32 s4, s4, 0x710000
    s_lshr_b32 s5, s40, 3
    s_mul_i32 s5, s5, 128
    s_add_u32 s5, s5, 0x710000
    v_and_b32 v10, 31, v1
    v_mul_u32_u24 v10, 4, v10
    v_lshlrev_b32 v9, 24, v1
    v_lshlrev_b32 v96, 12, v96
    v_lshl_add_u32 v96, v97, 1, v96
    s_mov_b32 s46, 0x1000
    s_mov_b32 s24, s12
    s_mov_b32 s25, s13
    s_mov_b32 s26, 0x1000000
    s_mov_b32 s27, 0x00020000
    s_mul_i32 s38, s17, 5120
    s_add_u32 s38, s38, 66560
    s_mul_i32 s42, s17, 33280
    v_mov_b32 v120, 0
    v_mov_b32 v121, 0
    v_mov_b32 v122, 0
    v_mov_b32 v123, 0
    v_min_u32 v15, 29, v1
    v_lshl_add_u32 v15, v15, 4, s38
    ds_write_b128 v15, v[120:123]
    v_and_b32 v15, 7, v1
    v_mul_u32_u24 v15, 4160, v15
    v_add_u32 v15, s42, v15
    ds_write_b128 v15, v[120:123] offset:4096
    v_and_b32 v12, 7, v3
    v_mul_u32_u24 v12, 4160, v12
    v_lshrrev_b32 v13, 3, v3
    v_add_u32 v13, v13, v4
    v_lshl_add_u32 v12, v13, 4, v12
    s_lshl_b32 s44, s18, 6
    s_sub_u32 s45, s42, s44
    s_add_u32 s45, s45, 64
    v_add_u32 v12, s45, v12
    v_lshlrev_b32 v13, 5, v3
    v_lshl_add_u32 v13, v4, 4, v13
    s_sub_u32 s45, s38, s44
    s_add_u32 s45, s45, 64
    v_add_u32 v13, s45, v13
    s_add_u32 s43, s42, 4080
    v_sub_u32 v7, s43, v5
    v_subrev_u32 v8, 1024, v7
    s_mov_b32 s49, 0xffff
    s_mov_b32 s51, 0xffff0000
    v_lshlrev_b32 v132, 4, v1
    s_lshl_b32 s14, s40, 8
    s_add_u32 s53, s14, 0x380000
    s_add_u32 s28, s12, s53
    s_addc_u32 s29, s13, 0
    s_sub_u32 s30, 0x1c0000, s14
    s_mov_b32 s31, 0x00020000
    v_lshrrev_b32 v134, 3, v1
    v_mul_u32_u24 v134, 57344, v134
    v_and_b32 v11, 7, v1
    v_lshl_add_u32 v134, v11, 4, v134
    s_mul_i32 s53, s16, 458752
    s_lshl_b32 s19, s40, 13
    s_lshl_b32 s14, s16, 10
    s_add_u32 s43, s19, s14
    s_add_u32 s43, s43, 0x1c0000
    s_add_u32 s44, s43, 4096
    s_lshl_b32 s45, s16, 12
    s_add_u32 s45, s45, 0x708000
    v_lshrrev_b32 v135, 5, v1
    v_mul_u32_u24 v135, 1152, v135
    v_bfe_u32 v11, v1, 1, 4
    v_lshl_add_u32 v135, v11, 4, v135
    v_and_b32 v11, 1, v1
    v_mul_u32_u24 v11, 640, v11
    v_sub_u32 v135, v135, v11
    s_mul_i32 s14, s16, 2304
    s_add_u32 s14, s14, 77440
    v_add_u32 v135, s14, v135
    s_mov_b32 s36, 0x05040100
    s_mov_b32 s37, 0x07060302
    s_mov_b32 s48, 0x1c0000
    s_mov_b32 s50, 0x1c1000
    v_add_u32 v11, 67040, v132
    s_mul_i32 s14, s16, 9216
    s_add_u32 s14, s14, 76800
    v_lshrrev_b32 v2, 5, v1
    v_lshlrev_b32 v2, 7, v2
    v_lshl_add_u32 v2, v1, 4, v2
    v_add_u32 v2, s14, v2
    s_waitcnt lgkmcnt(0)
    s_lshr_b32 s14, s41, 16
    s_and_b32 s15, s41, 0xffff
    s_cmp_eq_u32 s17, 0
    s_cselect_b32 s14, s15, s14
    s_cmp_eq_u32 s18, 0
    s_cselect_b32 s14, s14, 0
    s_lshl_b32 s15, s14, 16
    v_lshl_add_u32 v15, v4, 3, v3
    v_and_b32 v124, 1, v3
    v_cmp_eq_u32 vcc, 1, v124
    v_mov_b32 v124, s15
    v_mov_b32 v125, s14
    v_cndmask_b32 v124, v124, v125, vcc
    v_lshrrev_b32 v15, 1, v15
    v_cmp_eq_u32 vcc, 15, v15
    s_nop 1
    v_cndmask_b32 v128, 0, v124, vcc
    v_cmp_eq_u32 vcc, 14, v15
    s_nop 1
    v_cndmask_b32 v129, 0, v124, vcc
    v_cmp_eq_u32 vcc, 13, v15
    s_nop 1
    v_cndmask_b32 v130, 0, v124, vcc
    v_cmp_eq_u32 vcc, 12, v15
    s_nop 1
    v_cndmask_b32 v131, 0, v124, vcc
    s_waitcnt vmcnt(9)
    buffer_load_dword v140, v98, s[64:67], 0 offen offset:0
    buffer_load_dword v141, v98, s[64:67], 0 offen offset:896
    buffer_load_dword v142, v98, s[64:67], 0 offen offset:1792
    buffer_load_dword v143, v98, s[64:67], 0 offen offset:2688
    buffer_load_dword v144, v99, s[64:67], 0 offen offset:0
    buffer_load_dword v145, v99, s[64:67], 0 offen offset:896
    buffer_load_dword v146, v99, s[64:67], 0 offen offset:1792
    buffer_load_dword v147, v99, s[64:67], 0 offen offset:2688
    buffer_load_dwordx4 v[156:159], v176, s[64:67], 0 offen
    buffer_load_dwordx4 v[160:163], v176, s[64:67], 0 offen offset:896
    v_lshlrev_b32 v40, 16, v16
    v_and_b32 v41, s51, v16
    v_lshlrev_b32 v42, 16, v17
    v_and_b32 v43, s51, v17
    v_lshlrev_b32 v44, 16, v18
    v_and_b32 v45, s51, v18
    v_lshlrev_b32 v46, 16, v19
    v_and_b32 v47, s51, v19
    v_lshlrev_b32 v48, 16, v20
    v_and_b32 v49, s51, v20
    v_lshlrev_b32 v50, 16, v21
    v_and_b32 v51, s51, v21
    v_lshlrev_b32 v52, 16, v22
    v_and_b32 v53, s51, v22
    v_lshlrev_b32 v54, 16, v23
    v_and_b32 v55, s51, v23
    v_lshlrev_b32 v56, 16, v24
    v_and_b32 v57, s51, v24
    v_lshlrev_b32 v58, 16, v25
    v_and_b32 v59, s51, v25
    v_lshlrev_b32 v60, 16, v26
    v_and_b32 v61, s51, v26
    s_waitcnt vmcnt(18)
    v_lshlrev_b32 v62, 16, v36
    v_lshlrev_b32 v63, 16, v38
    v_and_b32 v64, s51, v36
    v_and_b32 v65, s51, v38
    v_lshlrev_b32 v66, 16, v37
    v_lshlrev_b32 v67, 16, v39
    v_and_b32 v68, s51, v37
    v_and_b32 v69, s51, v39
    v_pk_mul_f32 v[70:71], v[40:41], v[68:69]
    v_pk_mul_f32 v[72:73], v[42:43], v[68:69]
    v_pk_mul_f32 v[74:75], v[44:45], v[68:69]
    v_pk_mul_f32 v[76:77], v[46:47], v[68:69]
    v_pk_mul_f32 v[78:79], v[48:49], v[68:69]
    v_pk_mul_f32 v[80:81], v[50:51], v[68:69]
    v_pk_mul_f32 v[82:83], v[52:53], v[68:69]
    v_pk_mul_f32 v[84:85], v[54:55], v[68:69]
    v_pk_fma_f32 v[70:71], v[42:43], v[66:67], v[70:71]
    v_pk_fma_f32 v[72:73], v[44:45], v[66:67], v[72:73]
    v_pk_fma_f32 v[74:75], v[46:47], v[66:67], v[74:75]
    v_pk_fma_f32 v[76:77], v[48:49], v[66:67], v[76:77]
    v_pk_fma_f32 v[78:79], v[50:51], v[66:67], v[78:79]
    v_pk_fma_f32 v[80:81], v[52:53], v[66:67], v[80:81]
    v_pk_fma_f32 v[82:83], v[54:55], v[66:67], v[82:83]
    v_pk_fma_f32 v[84:85], v[56:57], v[66:67], v[84:85]
    v_pk_fma_f32 v[70:71], v[44:45], v[64:65], v[70:71]
    v_pk_fma_f32 v[72:73], v[46:47], v[64:65], v[72:73]
    v_pk_fma_f32 v[74:75], v[48:49], v[64:65], v[74:75]
    v_pk_fma_f32 v[76:77], v[50:51], v[64:65], v[76:77]
    v_pk_fma_f32 v[78:79], v[52:53], v[64:65], v[78:79]
    v_pk_fma_f32 v[80:81], v[54:55], v[64:65], v[80:81]
    v_pk_fma_f32 v[82:83], v[56:57], v[64:65], v[82:83]
    v_pk_fma_f32 v[84:85], v[58:59], v[64:65], v[84:85]
    v_pk_fma_f32 v[70:71], v[46:47], v[62:63], v[70:71]
    v_pk_fma_f32 v[72:73], v[48:49], v[62:63], v[72:73]
    v_pk_fma_f32 v[74:75], v[50:51], v[62:63], v[74:75]
    v_pk_fma_f32 v[76:77], v[52:53], v[62:63], v[76:77]
    v_pk_fma_f32 v[78:79], v[54:55], v[62:63], v[78:79]
    v_pk_fma_f32 v[80:81], v[56:57], v[62:63], v[80:81]
    v_pk_fma_f32 v[82:83], v[58:59], v[62:63], v[82:83]
    v_pk_fma_f32 v[84:85], v[60:61], v[62:63], v[84:85]
    s_waitcnt vmcnt(10)
    v_lshlrev_b32 v40, 16, v27
    v_and_b32 v41, s51, v27
    v_lshlrev_b32 v42, 16, v28
    v_and_b32 v43, s51, v28
    v_lshlrev_b32 v44, 16, v29
    v_and_b32 v45, s51, v29
    v_lshlrev_b32 v46, 16, v30
    v_and_b32 v47, s51, v30
    v_lshlrev_b32 v48, 16, v31
    v_and_b32 v49, s51, v31
    v_lshlrev_b32 v50, 16, v32
    v_and_b32 v51, s51, v32
    v_lshlrev_b32 v52, 16, v33
    v_and_b32 v53, s51, v33
    v_lshlrev_b32 v54, 16, v34
    v_and_b32 v55, s51, v34
    v_pk_mul_f32 v[70:71], v[70:71], v[40:41]
    v_pk_mul_f32 v[72:73], v[72:73], v[42:43]
    v_pk_mul_f32 v[74:75], v[74:75], v[44:45]
    v_pk_mul_f32 v[76:77], v[76:77], v[46:47]
    v_pk_mul_f32 v[78:79], v[78:79], v[48:49]
    v_pk_mul_f32 v[80:81], v[80:81], v[50:51]
    v_pk_mul_f32 v[82:83], v[82:83], v[52:53]
    v_pk_mul_f32 v[84:85], v[84:85], v[54:55]
    v_cvt_pk_bf16_f32 v86, v70, v72
    v_cvt_pk_bf16_f32 v87, v74, v76
    v_cvt_pk_bf16_f32 v88, v78, v80
    v_cvt_pk_bf16_f32 v89, v82, v84
    buffer_store_dwordx4 v[86:89], v96, s[24:27], 0 offen sc1
    v_cvt_pk_bf16_f32 v90, v71, v73
    v_cvt_pk_bf16_f32 v91, v75, v77
    v_cvt_pk_bf16_f32 v92, v79, v81
    v_cvt_pk_bf16_f32 v93, v83, v85
    buffer_store_dwordx4 v[90:93], v96, s[24:27], s46 offen sc1
    buffer_load_dword v14, off, s[32:35], 0 sc1
    buffer_load_dwordx4 v[104:107], v5, s[20:23], 0 offen offset:0
    buffer_load_dwordx4 v[108:111], v6, s[20:23], 0 offen
    buffer_load_dwordx4 v[112:115], v5, s[20:23], 0 offen offset:1024
    buffer_load_dwordx4 v[116:119], v5, s[20:23], 0 offen offset:1008
    s_mov_b32 s64, s12
    s_mov_b32 s65, s13
    s_mov_b32 s66, 0x1000000
    s_mov_b32 s67, 0x00020000
    s_waitcnt vmcnt(9)
    v_perm_b32 v148, v141, v140, s36
    v_perm_b32 v152, v141, v140, s37
    v_perm_b32 v149, v143, v142, s36
    v_perm_b32 v153, v143, v142, s37
    v_perm_b32 v150, v145, v144, s36
    v_perm_b32 v154, v145, v144, s37
    v_perm_b32 v151, v147, v146, s36
    v_perm_b32 v155, v147, v146, s37
    buffer_store_dwordx4 v[148:151], v96, s[64:67], s48 offen sc1
    buffer_store_dwordx4 v[152:155], v96, s[64:67], s50 offen sc1
    s_waitcnt vmcnt(6)
L_pc_nm:
    v_readfirstlane_b32 s3, v14
    s_cmp_lg_u32 s3, 0
    s_cbranch_scc1 L_pc_gm
    buffer_load_dword v14, off, s[32:35], 0 sc1
    s_sub_u32 s100, s100, 1
    s_cbranch_scc1 L_pc_end
    s_waitcnt vmcnt(0)
    s_branch L_pc_nm
L_pc_gm:
    s_add_u32 s32, s12, 0x13c0000
    s_addc_u32 s33, s13, 0
    s_mov_b32 s34, 0x40000
    s_mov_b32 s35, 0x00020000
    buffer_store_dword v14, v9, s[64:67], s4 offen sc1
    buffer_load_dwordx4 v[208:211], v240, s[56:59], 0 offen
    buffer_load_dwordx4 v[212:215], v240, s[60:63], 0 offen
    buffer_load_dwordx4 v[216:219], v241, s[56:59], 0 offen
    buffer_load_dwordx4 v[220:223], v241, s[60:63], 0 offen
    buffer_load_dwordx4 v[188:191], v240, s[56:59], s47 offen
    buffer_load_dwordx4 v[192:195], v240, s[60:63], s47 offen
    buffer_load_dwordx4 v[196:199], v241, s[56:59], s47 offen
    buffer_load_dwordx4 v[200:203], v241, s[60:63], s47 offen
    s_waitcnt vmcnt(13)
    v_alignbit_b32 v16, v107, v107, 16
    v_alignbit_b32 v17, v106, v106, 16
    v_alignbit_b32 v18, v105, v105, 16
    v_alignbit_b32 v19, v104, v104, 16
    v_alignbit_b32 v20, v111, v111, 16
    v_alignbit_b32 v21, v110, v110, 16
    v_bfi_b32 v32, s49, v107, v106
    v_bfi_b32 v33, s49, v106, v105
    v_bfi_b32 v34, s49, v105, v104
    v_bfi_b32 v35, s49, v104, v111
    v_bfi_b32 v36, s49, v111, v110
    v_bfi_b32 v37, s49, v110, v109
    v_alignbit_b32 v26, v106, v106, 16
    v_alignbit_b32 v27, v105, v105, 16
    v_alignbit_b32 v28, v104, v104, 16
    v_alignbit_b32 v29, v111, v111, 16
    v_alignbit_b32 v30, v110, v110, 16
    v_alignbit_b32 v31, v109, v109, 16
    v_bfi_b32 v42, s49, v106, v105
    v_bfi_b32 v43, s49, v105, v104
    v_bfi_b32 v44, s49, v104, v111
    v_bfi_b32 v45, s49, v111, v110
    v_bfi_b32 v46, s49, v110, v109
    v_bfi_b32 v47, s49, v109, v108
    ds_write_b128 v7, v[16:19] offset:0
    ds_write_b128 v7, v[32:35] offset:4160
    ds_write_b128 v7, v[26:29] offset:8320
    ds_write_b128 v7, v[42:45] offset:12480
    ds_write_b128 v7, v[18:21] offset:16640
    ds_write_b128 v7, v[34:37] offset:20800
    ds_write_b128 v7, v[28:31] offset:24960
    ds_write_b128 v7, v[44:47] offset:29120
    s_waitcnt vmcnt(11)
    v_alignbit_b32 v48, v115, v115, 16
    v_alignbit_b32 v49, v114, v114, 16
    v_alignbit_b32 v50, v113, v113, 16
    v_alignbit_b32 v51, v112, v112, 16
    v_alignbit_b32 v52, v119, v119, 16
    v_alignbit_b32 v53, v118, v118, 16
    v_bfi_b32 v64, s49, v115, v114
    v_bfi_b32 v65, s49, v114, v113
    v_bfi_b32 v66, s49, v113, v112
    v_bfi_b32 v67, s49, v112, v119
    v_bfi_b32 v68, s49, v119, v118
    v_bfi_b32 v69, s49, v118, v117
    v_alignbit_b32 v58, v114, v114, 16
    v_alignbit_b32 v59, v113, v113, 16
    v_alignbit_b32 v60, v112, v112, 16
    v_alignbit_b32 v61, v119, v119, 16
    v_alignbit_b32 v62, v118, v118, 16
    v_alignbit_b32 v63, v117, v117, 16
    v_bfi_b32 v74, s49, v114, v113
    v_bfi_b32 v75, s49, v113, v112
    v_bfi_b32 v76, s49, v112, v119
    v_bfi_b32 v77, s49, v119, v118
    v_bfi_b32 v78, s49, v118, v117
    v_bfi_b32 v79, s49, v117, v116
    ds_write_b128 v8, v[48:51] offset:0
    ds_write_b128 v8, v[64:67] offset:4160
    ds_write_b128 v8, v[58:61] offset:8320
    ds_write_b128 v8, v[74:77] offset:12480
    ds_write_b128 v8, v[50:53] offset:16640
    ds_write_b128 v8, v[66:69] offset:20800
    ds_write_b128 v8, v[60:63] offset:24960
    ds_write_b128 v8, v[76:79] offset:29120
    s_waitcnt vmcnt(9)
    s_add_u32 s4, s4, 0x20000
    buffer_store_dword v14, v9, s[64:67], s4 offen sc1
    s_waitcnt vmcnt(19)
    s_mov_b32 s15, 0x3f803f80
    v_dot2_f32_bf16 v164, v156, s15, 0
    v_dot2_f32_bf16 v165, v156, v156, 0
    v_dot2_f32_bf16 v166, v160, s15, 0
    v_dot2_f32_bf16 v167, v160, v160, 0
    v_dot2_f32_bf16 v164, v157, s15, v164
    v_dot2_f32_bf16 v165, v157, v157, v165
    v_dot2_f32_bf16 v166, v161, s15, v166
    v_dot2_f32_bf16 v167, v161, v161, v167
    v_dot2_f32_bf16 v164, v158, s15, v164
    v_dot2_f32_bf16 v165, v158, v158, v165
    v_dot2_f32_bf16 v166, v162, s15, v166
    v_dot2_f32_bf16 v167, v162, v162, v167
    v_dot2_f32_bf16 v164, v159, s15, v164
    v_dot2_f32_bf16 v165, v159, v159, v165
    v_dot2_f32_bf16 v166, v163, s15, v166
    v_dot2_f32_bf16 v167, v163, v163, v167
    v_add_f32_dpp v164, v164, v164 quad_perm:[1,0,3,2] row_mask:0xf bank_mask:0xf
    v_add_f32_dpp v165, v165, v165 quad_perm:[1,0,3,2] row_mask:0xf bank_mask:0xf
    v_add_f32_dpp v166, v166, v166 quad_perm:[1,0,3,2] row_mask:0xf bank_mask:0xf
    v_add_f32_dpp v167, v167, v167 quad_perm:[1,0,3,2] row_mask:0xf bank_mask:0xf
    v_add_f32_dpp v164, v164, v164 quad_perm:[2,3,0,1] row_mask:0xf bank_mask:0xf
    v_add_f32_dpp v165, v165, v165 quad_perm:[2,3,0,1] row_mask:0xf bank_mask:0xf
    v_add_f32_dpp v166, v166, v166 quad_perm:[2,3,0,1] row_mask:0xf bank_mask:0xf
    v_add_f32_dpp v167, v167, v167 quad_perm:[2,3,0,1] row_mask:0xf bank_mask:0xf
    v_add_f32_dpp v164, v164, v164 row_half_mirror row_mask:0xf bank_mask:0xf
    v_add_f32_dpp v165, v165, v165 row_half_mirror row_mask:0xf bank_mask:0xf
    v_add_f32_dpp v166, v166, v166 row_half_mirror row_mask:0xf bank_mask:0xf
    v_add_f32_dpp v167, v167, v167 row_half_mirror row_mask:0xf bank_mask:0xf
    v_add_f32_dpp v164, v164, v164 row_mirror row_mask:0xf bank_mask:0xf
    v_add_f32_dpp v165, v165, v165 row_mirror row_mask:0xf bank_mask:0xf
    v_add_f32_dpp v166, v166, v166 row_mirror row_mask:0xf bank_mask:0xf
    v_add_f32_dpp v167, v167, v167 row_mirror row_mask:0xf bank_mask:0xf
    v_add_f32_dpp v164, v164, v164 row_bcast:15 row_mask:0xa bank_mask:0xf
    v_add_f32_dpp v165, v165, v165 row_bcast:15 row_mask:0xa bank_mask:0xf
    v_add_f32_dpp v166, v166, v166 row_bcast:15 row_mask:0xa bank_mask:0xf
    v_add_f32_dpp v167, v167, v167 row_bcast:15 row_mask:0xa bank_mask:0xf
    v_add_f32_dpp v164, v164, v164 row_bcast:31 row_mask:0xc bank_mask:0xf
    v_add_f32_dpp v165, v165, v165 row_bcast:31 row_mask:0xc bank_mask:0xf
    v_add_f32_dpp v166, v166, v166 row_bcast:31 row_mask:0xc bank_mask:0xf
    v_add_f32_dpp v167, v167, v167 row_bcast:31 row_mask:0xc bank_mask:0xf
    v_mul_f32 v164, 0x3b124925, v164
    v_mul_f32 v165, 0x3b124925, v165
    v_fma_f32 v165, -v164, v164, v165
    v_max_f32 v165, 0, v165
    v_cvt_pk_bf16_f32 v168, v165, v165
    v_lshlrev_b32 v168, 16, v168
    v_add_f32 v168, 0x3727c5ac, v168
    v_cvt_pk_bf16_f32 v168, v168, v168
    v_lshlrev_b32 v168, 16, v168
    v_sqrt_f32 v168, v168
    s_nop 0
    v_cvt_pk_bf16_f32 v172, v164, v168
    v_mul_f32 v166, 0x3b124925, v166
    v_mul_f32 v167, 0x3b124925, v167
    v_fma_f32 v167, -v166, v166, v167
    v_max_f32 v167, 0, v167
    v_cvt_pk_bf16_f32 v170, v167, v167
    v_lshlrev_b32 v170, 16, v170
    v_add_f32 v170, 0x3727c5ac, v170
    v_cvt_pk_bf16_f32 v170, v170, v170
    v_lshlrev_b32 v170, 16, v170
    v_sqrt_f32 v170, v170
    s_nop 0
    v_cvt_pk_bf16_f32 v174, v166, v170
    v_mov_b32 v173, s3
    v_mov_b32 v175, s3
    s_mov_b32 s15, 0x708000
    buffer_store_dwordx4 v[172:175], v177, s[64:67], s15 offen sc1
    s_lshl_b32 s47, s16, 12
    s_add_u32 s47, s47, 106496
    v_lshrrev_b32 v181, 2, v1
    v_lshlrev_b32 v181, 7, v181
    v_bfe_u32 v6, v1, 3, 2
    v_lshl_add_u32 v181, v6, 5, v181
    v_and_b32 v6, 3, v1
    v_lshl_add_u32 v181, v6, 3, v181
    v_add_u32 v181, s47, v181
    v_xor_b32 v182, 32, v181
    v_xor_b32 v183, 64, v181
    v_xor_b32 v184, 96, v181
    s_add_u32 s60, s12, 0x1400000
    s_addc_u32 s61, s13, 0
    s_mov_b32 s62, 0x0
    s_mov_b32 s63, 0x00020000
    s_mov_b32 s46, 0
    s_cmp_lg_u32 s16, 0
    s_cbranch_scc1 L_pc_np
L_pc_poll:
    buffer_load_dword v124, v10, s[64:67], s5 offen sc1
L_pc_pw:
    s_sub_u32 s100, s100, 1
    s_cbranch_scc1 L_pc_end
    s_waitcnt vmcnt(0)
    v_cmp_ne_u32 vcc, s3, v124
    s_cbranch_vccz L_pc_go
    s_sleep 2
    s_branch L_pc_poll
L_pc_go:
    s_add_u32 s14, s19, 4096
    buffer_load_dwordx4 v[16:19], v132, s[64:67], s19 offen offset:0 sc1
    buffer_load_dwordx4 v[20:23], v132, s[64:67], s19 offen offset:1024 sc1
    buffer_load_dwordx4 v[24:27], v132, s[64:67], s19 offen offset:2048 sc1
    buffer_load_dwordx4 v[28:31], v132, s[64:67], s19 offen offset:3072 sc1
    buffer_load_dwordx4 v[32:35], v132, s[64:67], s14 offen offset:0 sc1
    buffer_load_dwordx4 v[36:39], v132, s[64:67], s14 offen offset:1024 sc1
    buffer_load_dwordx4 v[40:43], v132, s[64:67], s14 offen offset:2048 sc1
    buffer_load_dwordx4 v[44:47], v132, s[64:67], s14 offen offset:3072 sc1
    s_add_u32 s5, s5, 0x20000
    buffer_load_dword v124, v10, s[64:67], s5 offen sc1
    s_waitcnt vmcnt(8)
    ds_write_b128 v11, v[16:19] offset:0
    s_waitcnt vmcnt(7)
    ds_write_b128 v11, v[20:23] offset:1024
    s_waitcnt vmcnt(6)
    ds_write_b128 v11, v[24:27] offset:2048
    s_waitcnt vmcnt(5)
    ds_write_b128 v11, v[28:31] offset:3072
    s_waitcnt vmcnt(4)
    ds_write_b128 v11, v[32:35] offset:5120
    s_waitcnt vmcnt(3)
    ds_write_b128 v11, v[36:39] offset:6144
    s_waitcnt vmcnt(2)
    ds_write_b128 v11, v[40:43] offset:7168
    s_waitcnt vmcnt(1)
    ds_write_b128 v11, v[44:47] offset:8192
L_pc_xw:
    s_waitcnt vmcnt(0)
    v_cmp_ne_u32 vcc, s3, v124
    s_cbranch_vccz L_pc_bar
    buffer_load_dword v124, v10, s[64:67], s5 offen sc1
    s_sub_u32 s100, s100, 1
    s_cbranch_scc0 L_pc_xw
    s_branch L_pc_end
L_pc_np:
    s_waitcnt vmcnt(2)
    s_cmp_lt_u32 s16, 2
    s_cbranch_scc1 L_pc_nw
    s_lshl_b32 s38, s2, 1
    s_add_u32 s38, s38, s16
    s_sub_u32 s38, s38, 2
    s_mul_i32 s14, s38, 1338
    s_lshr_b32 s14, s14, 16
    s_mul_i32 s15, s14, 49
    s_sub_u32 s38, s38, s15
    s_mul_i32 s41, s38, 37
    s_lshr_b32 s41, s41, 8
    s_mul_i32 s42, s41, 7
    s_sub_u32 s42, s38, s42
    s_mul_i32 s38, s14, 28
    s_add_u32 s15, s38, s41
    s_mul_i32 s15, s15, 7168
    s_lshl_b32 s46, s42, 7
    s_add_u32 s15, s15, s46
    s_mov_b32 s10, 0x188000
    s_mov_b32 s11, 0x00020000
    v_lshrrev_b32 v180, 3, v1
    v_and_b32 v6, 7, v1
    v_and_b32 v7, 6, v180
    v_xor_b32 v6, v6, v7
    v_and_b32 v180, 3, v180
    v_lshrrev_b32 v7, 5, v1
    v_mad_u32_u24 v180, v7, 56, v180
    v_mul_u32_u24 v180, 896, v180
    v_lshl_add_u32 v180, v6, 4, v180
    s_add_u32 m0, s47, 0
    s_add_u32 s46, s15, 0
    buffer_load_dwordx4 v180, s[8:11], s46 offen lds
    s_add_u32 m0, s47, 1024
    s_add_u32 s46, s15, 100352
    buffer_load_dwordx4 v180, s[8:11], s46 offen lds
    s_add_u32 m0, s47, 2048
    s_add_u32 s46, s15, 3584
L_tp0:
    s_cbranch_execz L_tret
    buffer_load_dwordx4 v180, s[8:11], s46 offen lds
    s_add_u32 m0, s47, 3072
    s_add_u32 s46, s15, 103936
    buffer_load_dwordx4 v180, s[8:11], s46 offen lds
    s_lshl_b32 s42, s42, 2
    s_add_u32 s38, s38, s42
    s_mul_i32 s38, s38, 7
    s_add_u32 s38, s38, s41
    s_lshl_b32 s46, s38, 10
    s_mov_b32 s62, 0x188000
L_pc_nw:
    s_mul_i32 s14, s16, 4608
    s_add_u32 s14, s14, 118272
    v_xor_b32 v242, v4, v1
    v_lshl_add_u32 v240, v242, 4, s14
    v_swap_b32 v209, v212
    v_swap_b32 v211, v214
    ds_write_b128 v240, v[208:211] offset:0
    ds_write_b128 v240, v[212:215] offset:1088
    v_swap_b32 v217, v220
    v_swap_b32 v219, v222
    ds_write_b128 v240, v[216:219] offset:2304
    ds_write_b128 v240, v[220:223] offset:3392
    v_bfe_u32 v242, v1, 2, 3
    v_lshrrev_b32 v243, 1, v242
    v_lshrrev_b32 v244, 5, v1
    v_xor_b32 v243, v243, v244
    v_lshlrev_b32 v242, 7, v242
    v_lshl_add_u32 v242, v243, 4, v242
    v_bfe_u32 v243, v1, 1, 1
    v_lshl_add_u32 v242, v243, 3, v242
    v_xor_b32 v243, 32, v242
    v_and_b32 v241, 1, v1
    v_mul_u32_u24 v241, 1088, v241
    v_add3_u32 v242, v242, v241, s14
    v_add3_u32 v243, v243, v241, s14
    ds_read_b64_tr_b16 v[224:225], v242 offset:0
    ds_read_b64_tr_b16 v[226:227], v242 offset:2304
    ds_read_b64_tr_b16 v[228:229], v243 offset:0
    ds_read_b64_tr_b16 v[230:231], v243 offset:2304
    ds_read_b64_tr_b16 v[232:233], v242 offset:64
    ds_read_b64_tr_b16 v[234:235], v242 offset:2368
    ds_read_b64_tr_b16 v[236:237], v243 offset:64
    ds_read_b64_tr_b16 v[238:239], v243 offset:2368
    v_mul_u32_u24 v244, 14336, v244
    v_and_b32 v241, 31, v1
    v_lshl_add_u32 v244, v241, 4, v244
    v_add_u32 v245, 28672, v244
    v_add_u32 v246, 57344, v244
    v_add_u32 v247, 86016, v244
    s_mul_i32 s14, s82, 114688
    s_add_u32 s14, s14, 0x1000000
    s_add_u32 s68, s12, s14
    s_addc_u32 s69, s13, 0
    s_cmp_ge_u32 s2, 196
    s_cselect_b32 s70, 0, 114688
    s_lshl_b32 s14, s75, 9
    s_waitcnt lgkmcnt(6)
    buffer_store_dwordx4 v[224:227], v244, s[68:71], s14 offen offset:0 sc1
    s_waitcnt lgkmcnt(4)
    buffer_store_dwordx4 v[228:231], v245, s[68:71], s14 offen offset:0 sc1
    s_waitcnt lgkmcnt(2)
    buffer_store_dwordx4 v[232:235], v246, s[68:71], s14 offen offset:0 sc1
    s_waitcnt lgkmcnt(0)
    buffer_store_dwordx4 v[236:239], v247, s[68:71], s14 offen offset:0 sc1
    v_mov_b32 v241, 0
    s_cmp_lg_u32 s16, 1
    s_cbranch_scc1 L_pc_w1
    v_swap_b32 v189, v192
    v_swap_b32 v191, v194
    ds_write_b128 v240, v[188:191] offset:0
    ds_write_b128 v240, v[192:195] offset:1088
    v_swap_b32 v197, v200
    v_swap_b32 v199, v202
    ds_write_b128 v240, v[196:199] offset:2304
    ds_write_b128 v240, v[200:203] offset:3392
    ds_read_b64_tr_b16 v[208:209], v242 offset:0
    ds_read_b64_tr_b16 v[210:211], v242 offset:2304
    ds_read_b64_tr_b16 v[212:213], v243 offset:0
    ds_read_b64_tr_b16 v[214:215], v243 offset:2304
    ds_read_b64_tr_b16 v[216:217], v242 offset:64
    ds_read_b64_tr_b16 v[218:219], v242 offset:2368
    ds_read_b64_tr_b16 v[220:221], v243 offset:64
    ds_read_b64_tr_b16 v[222:223], v243 offset:2368
    v_and_b32 v241, 4, v1
    s_waitcnt lgkmcnt(6)
    buffer_store_dwordx4 v[208:211], v244, s[68:71], s14 offen offset:512 sc1
    s_waitcnt lgkmcnt(4)
    buffer_store_dwordx4 v[212:215], v245, s[68:71], s14 offen offset:512 sc1
    s_waitcnt lgkmcnt(2)
    buffer_store_dwordx4 v[216:219], v246, s[68:71], s14 offen offset:512 sc1
    s_waitcnt lgkmcnt(0)
    buffer_store_dwordx4 v[220:223], v247, s[68:71], s14 offen offset:512 sc1
L_pc_w1:
    s_lshl_b32 s14, s82, 5
    s_add_u32 s14, s14, s75
    s_lshl_b32 s14, s14, 2
    s_add_u32 s14, s14, 0x20000
    v_and_b32 v248, 3, v1
    v_lshl_add_u32 v248, v248, 12, s14
    v_add_u32 v248, v248, v241
    v_lshrrev_b32 v241, 3, v1
    v_lshl_add_u32 v248, v241, 24, v248
    s_add_u32 s52, s16, 3
    s_sub_u32 s52, s52, 1
    s_add_u32 s14, 3, 9
    s_min_u32 s39, s14, 26
    s_mov_b32 s55, 3
    s_mov_b32 s54, 1
    s_mov_b64 exec, 0
    s_branch L_tchk
L_tret1:
    s_mov_b64 exec, -1
L_pc_bar:
    s_waitcnt lgkmcnt(0)
    s_barrier
    buffer_load_dwordx4 v[72:75], v132, s[64:67], s43 offen sc1
    ds_read_b128 a[128:131], v12 offset:3968
    ds_read_b128 a[12:15], v13 offset:384
    ds_read_b128 a[144:147], v12 offset:3456
    ds_read_b128 a[28:31], v13 offset:896
    ds_read_b128 a[160:163], v12 offset:2944
    ds_read_b128 a[44:47], v13 offset:1408
    ds_read_b128 a[176:179], v12 offset:2432
    ds_read_b128 a[60:63], v13 offset:1920
    ds_read_b128 a[192:195], v12 offset:1920
    ds_read_b128 a[76:79], v13 offset:2432
    ds_read_b128 a[208:211], v12 offset:1408
    ds_read_b128 a[92:95], v13 offset:2944
    ds_read_b128 a[224:227], v12 offset:896
    ds_read_b128 a[108:111], v13 offset:3456
    ds_read_b128 a[240:243], v12 offset:384
    s_waitcnt lgkmcnt(13)
    v_mfma_f32_16x16x32_bf16 v[16:19], a[128:131], a[12:15], 0
    buffer_load_dwordx4 v[76:79], v132, s[64:67], s44 offen sc1
    ds_read_b128 a[124:127], v13 offset:3968
    s_waitcnt lgkmcnt(13)
    v_mfma_f32_16x16x32_bf16 v[20:23], a[144:147], a[12:15], 0
    buffer_load_dwordx4 v[80:83], v132, s[64:67], s45 offen offset:0 sc1
    ds_read_b128 a[132:135], v12 offset:3840
    s_waitcnt lgkmcnt(13)
    v_mfma_f32_16x16x32_bf16 v[24:27], a[144:147], a[28:31], 0
    v_mfma_f32_16x16x32_bf16 v[16:19], v[128:131], a[12:15], v[16:19]
    buffer_load_dwordx4 v[84:87], v132, s[64:67], s45 offen offset:1024 sc1
    v_mfma_f32_16x16x32_bf16 v[20:23], a[128:131], a[28:31], v[20:23]
    buffer_load_dwordx4 v[88:91], v132, s[64:67], s45 offen offset:2048 sc1
    ds_read_b128 a[8:11], v13 offset:256
    s_waitcnt lgkmcnt(13)
    v_mfma_f32_16x16x32_bf16 v[24:27], a[160:163], a[12:15], v[24:27]
    buffer_load_dwordx4 v[92:95], v132, s[64:67], s45 offen offset:3072 sc1
    v_mfma_f32_16x16x32_bf16 v[28:31], a[160:163], a[28:31], 0
    v_mfma_f32_16x16x32_bf16 v[20:23], v[128:131], a[28:31], v[20:23]
    v_and_b32 v133, 15, v1
    v_mul_u32_u24 v133, 7168, v133
    ds_read_b128 a[148:151], v12 offset:3328
    s_waitcnt lgkmcnt(9)
    v_mfma_f32_16x16x32_bf16 v[32:35], a[160:163], a[44:47], 0
    v_lshrrev_b32 v136, 4, v1
    v_lshl_add_u32 v133, v136, 24, v133
    v_mfma_f32_16x16x32_bf16 v[24:27], a[128:131], a[44:47], v[24:27]
    s_and_b32 s15, s2, 1
    s_lshl_b32 s15, s15, 3
    v_mfma_f32_16x16x32_bf16 v[28:31], a[144:147], a[44:47], v[28:31]
    s_bfe_u32 s17, s2, 0x30003
    s_or_b32 s15, s15, s17
    ds_read_b128 a[164:167], v12 offset:2816
    v_mfma_f32_16x16x32_bf16 v[28:31], a[176:179], a[12:15], v[28:31]
    v_mfma_f32_16x16x32_bf16 v[24:27], v[128:131], a[44:47], v[24:27]
    s_bfe_u32 s14, s2, 0x20001
    s_lshl_b32 s14, s14, 2
    v_mfma_f32_16x16x32_bf16 v[32:35], a[176:179], a[28:31], v[32:35]
L_tp1:
    s_cbranch_execz L_tret
    s_lshr_b32 s17, s2, 6
    s_or_b32 s14, s14, s17
    v_mfma_f32_16x16x32_bf16 v[36:39], a[176:179], a[44:47], 0
    s_and_b32 s38, s16, 1
    s_lshr_b32 s17, s16, 1
    ds_read_b128 a[180:183], v12 offset:2304
    v_mfma_f32_16x16x32_bf16 v[40:43], a[176:179], a[60:63], 0
    s_lshl_b32 s41, s15, 1
    s_add_u32 s41, s41, s17
    v_mfma_f32_16x16x32_bf16 v[28:31], a[128:131], a[60:63], v[28:31]
    s_mul_i32 s42, s41, 100352
    s_mul_i32 s15, s38, 7168
    v_mfma_f32_16x16x32_bf16 v[32:35], a[144:147], a[60:63], v[32:35]
    s_add_u32 s42, s42, s15
    s_add_u32 s42, s42, 0x1000000
    v_mfma_f32_16x16x32_bf16 v[36:39], a[160:163], a[60:63], v[36:39]
    v_mfma_f32_16x16x32_bf16 v[28:31], v[128:131], a[60:63], v[28:31]
    s_add_u32 s24, s12, s42
    s_addc_u32 s25, s13, 0
    ds_read_b128 a[196:199], v12 offset:1792
    v_mfma_f32_16x16x32_bf16 v[32:35], a[192:195], a[12:15], v[32:35]
    s_mov_b32 s26, 93184
    s_mul_i32 s42, s41, 448
    v_mfma_f32_16x16x32_bf16 v[36:39], a[192:195], a[28:31], v[36:39]
    s_add_u32 s42, s42, 0x1380000
    s_add_u32 s76, s12, s42
    s_addc_u32 s77, s13, 0
    v_mfma_f32_16x16x32_bf16 v[40:43], a[192:195], a[44:47], v[40:43]
    s_mov_b32 s78, 448
    s_lshl_b32 s14, s14, 1
    v_mfma_f32_16x16x32_bf16 v[44:47], a[192:195], a[60:63], 0
    s_add_u32 s14, s14, s38
    s_lshl_b32 s14, s14, 3
    ds_read_b128 a[212:215], v12 offset:1280
    v_mfma_f32_16x16x32_bf16 v[32:35], a[128:131], a[76:79], v[32:35]
    s_lshr_b32 s15, s41, 2
    s_add_u32 s14, s14, s15
    v_mfma_f32_16x16x32_bf16 v[36:39], a[144:147], a[76:79], v[36:39]
    s_mul_i32 s14, s14, 28672
    s_add_u32 s14, s14, 0x1800000
    v_mfma_f32_16x16x32_bf16 v[40:43], a[160:163], a[76:79], v[40:43]
    v_mfma_f32_16x16x32_bf16 v[32:35], v[128:131], a[76:79], v[32:35]
    s_add_u32 s20, s12, s14
    s_addc_u32 s21, s13, 0
    v_mfma_f32_16x16x32_bf16 v[44:47], a[176:179], a[76:79], v[44:47]
    s_mov_b32 s22, 28672
    s_mov_b32 s23, 0x00020000
    ds_read_b128 a[228:231], v12 offset:768
    s_waitcnt lgkmcnt(9)
    v_mfma_f32_16x16x32_bf16 v[36:39], a[208:211], a[12:15], v[36:39]
    s_mov_b32 s27, 0x00020000
    s_mov_b32 s79, 0x00020000
    v_mfma_f32_16x16x32_bf16 v[40:43], a[208:211], a[28:31], v[40:43]
    s_mul_i32 s14, s41, 7
    v_bfe_u32 v250, v1, 4, 1
    v_mfma_f32_16x16x32_bf16 v[44:47], a[208:211], a[44:47], v[44:47]
    v_mad_u32_u24 v250, v250, 6, s14
    v_lshrrev_b32 v250, 3, v250
    ds_read_b128 a[244:247], v12 offset:256
    v_mfma_f32_16x16x32_bf16 v[36:39], a[128:131], a[92:95], v[36:39]
    s_mul_i32 s14, s38, 14
    v_and_b32 v15, 15, v1
    v_mfma_f32_16x16x32_bf16 v[40:43], a[144:147], a[92:95], v[40:43]
    v_min_u32 v15, 13, v15
    v_add_u32 v15, s14, v15
    v_mfma_f32_16x16x32_bf16 v[44:47], a[160:163], a[92:95], v[44:47]
    v_mfma_f32_16x16x32_bf16 v[36:39], v[128:131], a[92:95], v[36:39]
    v_lshl_add_u32 v15, v250, 5, v15
    s_and_b32 s14, s2, 3
    ds_read_b128 a[24:27], v13 offset:768
    v_mfma_f32_16x16x32_bf16 v[40:43], a[224:227], a[12:15], v[40:43]
    s_lshl_b32 s14, s14, 12
    s_add_u32 s14, s14, 0x20000
    v_mfma_f32_16x16x32_bf16 v[44:47], a[224:227], a[28:31], v[44:47]
    v_lshl_add_u32 v15, v15, 2, s14
    s_cmp_ge_u32 s40, 112
    s_cselect_b32 s14, 112, 0
    s_cselect_b32 s15, 56, 0
    ds_read_b128 a[120:123], v13 offset:3840
    v_mfma_f32_16x16x32_bf16 v[40:43], a[128:131], a[108:111], v[40:43]
    s_sub_u32 s14, s40, s14
    s_mul_i32 s17, s16, 224
    v_mfma_f32_16x16x32_bf16 v[44:47], a[144:147], a[108:111], v[44:47]
    s_add_u32 s15, s15, s17
    s_and_b32 s17, s14, 8
    ds_read_b128 a[40:43], v13 offset:1280
    v_mfma_f32_16x16x32_bf16 v[44:47], a[240:243], a[12:15], v[44:47]
    v_mfma_f32_16x16x32_bf16 v[40:43], v[128:131], a[108:111], v[40:43]
    s_mul_i32 s17, s17, 14
    s_add_u32 s15, s15, s17
    ds_read_b128 a[104:107], v13 offset:3328
    s_waitcnt lgkmcnt(9)
    v_mfma_f32_16x16x32_bf16 v[44:47], a[128:131], a[124:127], v[44:47]
    s_lshr_b32 s17, s14, 4
    s_lshl_b32 s17, s17, 3
    ds_read_b128 a[56:59], v13 offset:1792
    ds_read_b128 a[72:75], v13 offset:2304
    v_mfma_f32_16x16x32_bf16 v[16:19], a[132:135], a[8:11], v[16:19]
    s_add_u32 s15, s15, s17
    s_and_b32 s17, s14, 7
    ds_read_b128 a[88:91], v13 offset:2816
    v_mfma_f32_16x16x32_bf16 v[20:23], a[148:151], a[8:11], v[20:23]
    v_mfma_f32_16x16x32_bf16 v[44:47], v[128:131], a[124:127], v[44:47]
    s_add_u32 s15, s15, s17
    s_mul_i32 s15, s15, 8
    ds_read_b128 a[136:139], v12 offset:3712
    v_mfma_f32_16x16x32_bf16 v[24:27], a[164:167], a[8:11], v[24:27]
    s_add_u32 s15, s15, 0x24000
    v_add_u32 v133, s15, v133
    ds_read_b128 a[4:7], v13 offset:128
    s_waitcnt lgkmcnt(9)
    v_mfma_f32_16x16x32_bf16 v[28:31], a[180:183], a[8:11], v[28:31]
    ds_read_b128 a[152:155], v12 offset:3200
    v_mfma_f32_16x16x32_bf16 v[32:35], a[196:199], a[8:11], v[32:35]
    ds_read_b128 a[168:171], v12 offset:2688
    v_mfma_f32_16x16x32_bf16 v[36:39], a[212:215], a[8:11], v[36:39]
    s_waitcnt vmcnt(6)
    buffer_store_dword v14, v248, s[32:35], 0 offen sc1
    ds_read_b64_tr_b16 v[188:189], v181 offset:0
    ds_read_b128 a[184:187], v12 offset:2176
    v_mfma_f32_16x16x32_bf16 v[40:43], a[228:231], a[8:11], v[40:43]
    ds_read_b64_tr_b16 v[190:191], v181 offset:2048
    ds_read_b128 a[200:203], v12 offset:1664
    v_mfma_f32_16x16x32_bf16 v[44:47], a[244:247], a[8:11], v[44:47]
    ds_read_b64_tr_b16 v[192:193], v182 offset:0
    ds_read_b128 a[216:219], v12 offset:1152
    s_waitcnt lgkmcnt(12)
    v_mfma_f32_16x16x32_bf16 v[20:23], a[132:135], a[24:27], v[20:23]
    ds_read_b64_tr_b16 v[194:195], v182 offset:2048
    ds_read_b128 a[232:235], v12 offset:640
    v_mfma_f32_16x16x32_bf16 v[44:47], a[132:135], a[120:123], v[44:47]
    ds_read_b64_tr_b16 v[196:197], v183 offset:0
    v_mfma_f32_16x16x32_bf16 v[24:27], a[148:151], a[24:27], v[24:27]
    ds_read_b64_tr_b16 v[198:199], v183 offset:2048
    v_mfma_f32_16x16x32_bf16 v[28:31], a[164:167], a[24:27], v[28:31]
    ds_read_b64_tr_b16 v[200:201], v184 offset:0
    v_mfma_f32_16x16x32_bf16 v[32:35], a[180:183], a[24:27], v[32:35]
    ds_read_b64_tr_b16 v[202:203], v184 offset:2048
    v_mfma_f32_16x16x32_bf16 v[36:39], a[196:199], a[24:27], v[36:39]
    v_mfma_f32_16x16x32_bf16 v[40:43], a[212:215], a[24:27], v[40:43]
    v_mfma_f32_16x16x32_bf16 v[44:47], a[228:231], a[24:27], v[44:47]
    ds_read_b128 a[248:251], v12 offset:128
    v_mfma_f32_16x16x32_bf16 v[24:27], a[132:135], a[40:43], v[24:27]
    ds_read_b128 a[20:23], v13 offset:640
    v_mfma_f32_16x16x32_bf16 v[40:43], a[132:135], a[104:107], v[40:43]
    s_waitcnt lgkmcnt(11)
    buffer_store_dwordx4 v[188:191], v132, s[60:63], s46 offen sc1
    s_add_u32 s46, s46, 7168
    v_mfma_f32_16x16x32_bf16 v[28:31], a[148:151], a[40:43], v[28:31]
    v_mfma_f32_16x16x32_bf16 v[32:35], a[164:167], a[40:43], v[32:35]
    v_mfma_f32_16x16x32_bf16 v[36:39], a[180:183], a[40:43], v[36:39]
    s_waitcnt lgkmcnt(7)
    buffer_store_dwordx4 v[192:195], v132, s[60:63], s46 offen sc1
    s_add_u32 s46, s46, 7168
    v_mfma_f32_16x16x32_bf16 v[40:43], a[196:199], a[40:43], v[40:43]
    v_mfma_f32_16x16x32_bf16 v[44:47], a[212:215], a[40:43], v[44:47]
    ds_read_b128 a[116:119], v13 offset:3712
    v_mfma_f32_16x16x32_bf16 v[28:31], a[132:135], a[56:59], v[28:31]
    s_waitcnt lgkmcnt(5)
    buffer_store_dwordx4 v[196:199], v132, s[60:63], s46 offen sc1
    s_add_u32 s46, s46, 7168
    v_mfma_f32_16x16x32_bf16 v[44:47], a[148:151], a[104:107], v[44:47]
L_tp2:
    s_cbranch_execz L_tret
    v_mfma_f32_16x16x32_bf16 v[32:35], a[148:151], a[56:59], v[32:35]
    v_mfma_f32_16x16x32_bf16 v[36:39], a[164:167], a[56:59], v[36:39]
    s_waitcnt lgkmcnt(3)
    buffer_store_dwordx4 v[200:203], v132, s[60:63], s46 offen sc1
    s_add_u32 s46, s46, 7168
    v_mfma_f32_16x16x32_bf16 v[40:43], a[180:183], a[56:59], v[40:43]
    v_mfma_f32_16x16x32_bf16 v[44:47], a[196:199], a[56:59], v[44:47]
    ds_read_b128 a[36:39], v13 offset:1152
    v_mfma_f32_16x16x32_bf16 v[32:35], a[132:135], a[72:75], v[32:35]
    v_mfma_f32_16x16x32_bf16 v[36:39], a[148:151], a[72:75], v[36:39]
    v_mfma_f32_16x16x32_bf16 v[40:43], a[164:167], a[72:75], v[40:43]
    v_mfma_f32_16x16x32_bf16 v[44:47], a[180:183], a[72:75], v[44:47]
    ds_read_b128 a[100:103], v13 offset:3200
    v_mfma_f32_16x16x32_bf16 v[36:39], a[132:135], a[88:91], v[36:39]
    v_mfma_f32_16x16x32_bf16 v[40:43], a[148:151], a[88:91], v[40:43]
    v_mfma_f32_16x16x32_bf16 v[44:47], a[164:167], a[88:91], v[44:47]
    ds_read_b128 a[52:55], v13 offset:1664
    ds_read_b128 a[68:71], v13 offset:2176
    v_mfma_f32_16x16x32_bf16 v[16:19], a[136:139], a[4:7], v[16:19]
    ds_read_b128 a[84:87], v13 offset:2688
    v_mfma_f32_16x16x32_bf16 v[20:23], a[152:155], a[4:7], v[20:23]
    ds_read_b128 a[140:143], v12 offset:3584
    v_mfma_f32_16x16x32_bf16 v[24:27], a[168:171], a[4:7], v[24:27]
    ds_read_b128 a[0:3], v13 offset:0
    v_mfma_f32_16x16x32_bf16 v[28:31], a[184:187], a[4:7], v[28:31]
    ds_read_b128 a[156:159], v12 offset:3072
    v_mfma_f32_16x16x32_bf16 v[32:35], a[200:203], a[4:7], v[32:35]
    ds_read_b128 a[172:175], v12 offset:2560
    v_mfma_f32_16x16x32_bf16 v[36:39], a[216:219], a[4:7], v[36:39]
    ds_read_b128 a[188:191], v12 offset:2048
    v_mfma_f32_16x16x32_bf16 v[40:43], a[232:235], a[4:7], v[40:43]
    ds_read_b128 a[204:207], v12 offset:1536
    s_waitcnt lgkmcnt(9)
    v_mfma_f32_16x16x32_bf16 v[44:47], a[248:251], a[4:7], v[44:47]
    ds_read_b128 a[220:223], v12 offset:1024
    v_mfma_f32_16x16x32_bf16 v[20:23], a[136:139], a[20:23], v[20:23]
    ds_read_b128 a[236:239], v12 offset:512
    v_mfma_f32_16x16x32_bf16 v[44:47], a[136:139], a[116:119], v[44:47]
    v_mfma_f32_16x16x32_bf16 v[24:27], a[152:155], a[20:23], v[24:27]
    v_mfma_f32_16x16x32_bf16 v[28:31], a[168:171], a[20:23], v[28:31]
    s_waitcnt vmcnt(5)
    v_and_b32 v6, v81, v83
    v_or_b32 v7, v81, v83
    v_mfma_f32_16x16x32_bf16 v[32:35], a[184:187], a[20:23], v[32:35]
    v_bitop3_b32 v6, v85, v87, v6 bitop3:0x80
    v_or3_b32 v7, v85, v87, v7
    v_mfma_f32_16x16x32_bf16 v[36:39], a[200:203], a[20:23], v[36:39]
    v_bitop3_b32 v6, v89, v91, v6 bitop3:0x80
    v_or3_b32 v7, v89, v91, v7
    v_mfma_f32_16x16x32_bf16 v[40:43], a[216:219], a[20:23], v[40:43]
    v_bitop3_b32 v6, v93, v95, v6 bitop3:0x80
    v_or3_b32 v7, v93, v95, v7
    v_mfma_f32_16x16x32_bf16 v[44:47], a[232:235], a[20:23], v[44:47]
    v_xor_b32 v6, s3, v6
    v_xor_b32 v7, s3, v7
    ds_read_b128 a[252:255], v12 offset:0
    v_mfma_f32_16x16x32_bf16 v[24:27], a[136:139], a[36:39], v[24:27]
    v_or_b32 v6, v6, v7
    v_cmp_ne_u32 vcc, 0, v6
    ds_read_b128 a[16:19], v13 offset:512
    v_mfma_f32_16x16x32_bf16 v[40:43], a[136:139], a[100:103], v[40:43]
    s_cbranch_vccnz L_pc_sl
L_pc_sb:
    v_lshlrev_b32 v112, 16, v72
    v_mfma_f32_16x16x32_bf16 v[28:31], a[152:155], a[36:39], v[28:31]
    v_and_b32 v113, s51, v72
    v_lshlrev_b32 v114, 16, v73
    v_mfma_f32_16x16x32_bf16 v[32:35], a[168:171], a[36:39], v[32:35]
    v_and_b32 v115, s51, v73
    v_lshlrev_b32 v116, 16, v74
    v_mfma_f32_16x16x32_bf16 v[36:39], a[184:187], a[36:39], v[36:39]
    v_and_b32 v117, s51, v74
    v_lshlrev_b32 v118, 16, v75
    v_mfma_f32_16x16x32_bf16 v[40:43], a[200:203], a[36:39], v[40:43]
    v_and_b32 v119, s51, v75
    v_lshlrev_b32 v120, 16, v76
    v_mfma_f32_16x16x32_bf16 v[44:47], a[216:219], a[36:39], v[44:47]
    v_and_b32 v121, s51, v76
    v_lshlrev_b32 v122, 16, v77
    ds_read_b128 a[112:115], v13 offset:3584
    s_waitcnt lgkmcnt(9)
    v_mfma_f32_16x16x32_bf16 v[28:31], a[136:139], a[52:55], v[28:31]
    v_and_b32 v123, s51, v77
    v_lshlrev_b32 v124, 16, v78
    v_mfma_f32_16x16x32_bf16 v[44:47], a[152:155], a[100:103], v[44:47]
    v_and_b32 v125, s51, v78
    v_lshlrev_b32 v126, 16, v79
    v_mfma_f32_16x16x32_bf16 v[32:35], a[152:155], a[52:55], v[32:35]
    v_and_b32 v127, s51, v79
    v_and_b32 v81, s51, v80
    v_mfma_f32_16x16x32_bf16 v[36:39], a[168:171], a[52:55], v[36:39]
    v_lshlrev_b32 v80, 16, v80
    v_and_b32 v83, s51, v82
    v_mfma_f32_16x16x32_bf16 v[40:43], a[184:187], a[52:55], v[40:43]
    v_lshlrev_b32 v82, 16, v82
    v_and_b32 v85, s51, v84
    v_mfma_f32_16x16x32_bf16 v[44:47], a[200:203], a[52:55], v[44:47]
    v_lshlrev_b32 v84, 16, v84
    v_and_b32 v87, s51, v86
    ds_read_b128 a[32:35], v13 offset:1024
    v_mfma_f32_16x16x32_bf16 v[32:35], a[136:139], a[68:71], v[32:35]
    v_lshlrev_b32 v86, 16, v86
    v_and_b32 v89, s51, v88
    v_mfma_f32_16x16x32_bf16 v[36:39], a[152:155], a[68:71], v[36:39]
    v_lshlrev_b32 v88, 16, v88
    v_and_b32 v91, s51, v90
    v_mfma_f32_16x16x32_bf16 v[40:43], a[168:171], a[68:71], v[40:43]
    v_lshlrev_b32 v90, 16, v90
    v_and_b32 v93, s51, v92
    v_mfma_f32_16x16x32_bf16 v[44:47], a[184:187], a[68:71], v[44:47]
    v_lshlrev_b32 v92, 16, v92
    v_and_b32 v95, s51, v94
    ds_read_b128 a[96:99], v13 offset:3072
    v_mfma_f32_16x16x32_bf16 v[36:39], a[136:139], a[84:87], v[36:39]
    v_lshlrev_b32 v94, 16, v94
    v_mfma_f32_16x16x32_bf16 v[40:43], a[152:155], a[84:87], v[40:43]
    v_rcp_f32 v81, v81
    v_mfma_f32_16x16x32_bf16 v[44:47], a[168:171], a[84:87], v[44:47]
    v_rcp_f32 v83, v83
    ds_read_b128 a[48:51], v13 offset:1536
    ds_read_b128 a[64:67], v13 offset:2048
    v_mfma_f32_16x16x32_bf16 v[16:19], a[140:143], a[0:3], v[16:19]
    v_rcp_f32 v85, v85
    ds_read_b128 a[80:83], v13 offset:2560
    s_waitcnt lgkmcnt(9)
    v_mfma_f32_16x16x32_bf16 v[20:23], a[156:159], a[0:3], v[20:23]
    v_rcp_f32 v87, v87
    v_mfma_f32_16x16x32_bf16 v[24:27], a[172:175], a[0:3], v[24:27]
    v_rcp_f32 v89, v89
    v_mfma_f32_16x16x32_bf16 v[28:31], a[188:191], a[0:3], v[28:31]
    v_rcp_f32 v91, v91
    v_mfma_f32_16x16x32_bf16 v[32:35], a[204:207], a[0:3], v[32:35]
    v_rcp_f32 v93, v93
    v_mfma_f32_16x16x32_bf16 v[36:39], a[220:223], a[0:3], v[36:39]
    v_rcp_f32 v95, v95
    s_waitcnt lgkmcnt(4)
    v_mfma_f32_16x16x32_bf16 v[40:43], a[236:239], a[0:3], v[40:43]
    v_mul_f32 v80, v80, v81
    v_mul_f32 v82, v82, v83
    v_mfma_f32_16x16x32_bf16 v[44:47], a[252:255], a[0:3], v[44:47]
    ds_write_b128 v2, v[16:19] offset:0
    v_mul_f32 v84, v84, v85
    v_mul_f32 v86, v86, v87
    v_mfma_f32_16x16x32_bf16 v[20:23], a[140:143], a[16:19], v[20:23]
    v_mul_f32 v88, v88, v89
    v_mul_f32 v90, v90, v91
    v_mfma_f32_16x16x32_bf16 v[44:47], a[140:143], a[112:115], v[44:47]
    v_mul_f32 v92, v92, v93
    v_mul_f32 v94, v94, v95
    v_mfma_f32_16x16x32_bf16 v[24:27], a[156:159], a[16:19], v[24:27]
    v_fma_f32 v96, v112, v81, -v80
    v_fma_f32 v97, v113, v83, -v82
    v_mfma_f32_16x16x32_bf16 v[28:31], a[172:175], a[16:19], v[28:31]
    v_fma_f32 v98, v114, v85, -v84
    v_fma_f32 v99, v115, v87, -v86
    v_mfma_f32_16x16x32_bf16 v[32:35], a[188:191], a[16:19], v[32:35]
    v_fma_f32 v100, v116, v89, -v88
    v_fma_f32 v101, v117, v91, -v90
    v_mfma_f32_16x16x32_bf16 v[36:39], a[204:207], a[16:19], v[36:39]
    v_fma_f32 v102, v118, v93, -v92
    v_fma_f32 v103, v119, v95, -v94
    v_mfma_f32_16x16x32_bf16 v[40:43], a[220:223], a[16:19], v[40:43]
    v_fma_f32 v104, v120, v81, -v80
    v_fma_f32 v105, v121, v83, -v82
L_tp3:
    s_cbranch_execz L_tret
    v_mfma_f32_16x16x32_bf16 v[44:47], a[236:239], a[16:19], v[44:47]
    ds_write_b128 v2, v[20:23] offset:1152
    v_fma_f32 v106, v122, v85, -v84
    v_fma_f32 v107, v123, v87, -v86
    v_mfma_f32_16x16x32_bf16 v[24:27], a[140:143], a[32:35], v[24:27]
    v_fma_f32 v108, v124, v89, -v88
    v_fma_f32 v109, v125, v91, -v90
    s_waitcnt lgkmcnt(2)
    v_mfma_f32_16x16x32_bf16 v[40:43], a[140:143], a[96:99], v[40:43]
    v_fma_f32 v110, v126, v93, -v92
    v_fma_f32 v111, v127, v95, -v94
    v_mfma_f32_16x16x32_bf16 v[28:31], a[156:159], a[32:35], v[28:31]
    v_mfma_f32_16x16x32_bf16 v[32:35], a[172:175], a[32:35], v[32:35]
    v_mfma_f32_16x16x32_bf16 v[36:39], a[188:191], a[32:35], v[36:39]
    v_mfma_f32_16x16x32_bf16 v[40:43], a[204:207], a[32:35], v[40:43]
    v_mfma_f32_16x16x32_bf16 v[44:47], a[220:223], a[32:35], v[44:47]
    v_mfma_f32_16x16x32_bf16 v[28:31], a[140:143], a[48:51], v[28:31]
    ds_write_b128 v2, v[24:27] offset:2304
    v_mfma_f32_16x16x32_bf16 v[44:47], a[156:159], a[96:99], v[44:47]
    v_mfma_f32_16x16x32_bf16 v[32:35], a[156:159], a[48:51], v[32:35]
    v_mfma_f32_16x16x32_bf16 v[36:39], a[172:175], a[48:51], v[36:39]
    v_mfma_f32_16x16x32_bf16 v[40:43], a[188:191], a[48:51], v[40:43]
    v_mfma_f32_16x16x32_bf16 v[44:47], a[204:207], a[48:51], v[44:47]
    v_mfma_f32_16x16x32_bf16 v[32:35], a[140:143], a[64:67], v[32:35]
    v_mfma_f32_16x16x32_bf16 v[36:39], a[156:159], a[64:67], v[36:39]
    ds_write_b128 v2, v[28:31] offset:3456
    v_mfma_f32_16x16x32_bf16 v[40:43], a[172:175], a[64:67], v[40:43]
    v_mfma_f32_16x16x32_bf16 v[44:47], a[188:191], a[64:67], v[44:47]
    v_mfma_f32_16x16x32_bf16 v[36:39], a[140:143], a[80:83], v[36:39]
    v_mfma_f32_16x16x32_bf16 v[40:43], a[156:159], a[80:83], v[40:43]
    buffer_load_dword v10, v15, s[32:35], 0 offen sc1
    v_mfma_f32_16x16x32_bf16 v[44:47], a[172:175], a[80:83], v[44:47]
    ds_write_b128 v2, v[32:35] offset:4608
    s_nop 3
    ds_write_b128 v2, v[36:39] offset:5760
    ds_write_b128 v2, v[40:43] offset:6912
    s_nop 0
    ds_write_b128 v2, v[44:47] offset:8064
    s_waitcnt vmcnt(1)
    s_waitcnt lgkmcnt(0)
    s_barrier
    ds_read_b128 v[16:19], v135 offset:256
    ds_read_b128 v[20:23], v135 offset:9472
    ds_read_b128 v[24:27], v135 offset:0
    ds_read_b128 v[28:31], v135 offset:9216
    ds_read_b128 v[32:35], v135 offset:18688
    ds_read_b128 v[36:39], v135 offset:27904
    ds_read_b128 v[40:43], v135 offset:18432
    ds_read_b128 v[44:47], v135 offset:27648
    s_waitcnt lgkmcnt(6)
    v_add_f32 v16, v16, v20
    v_add_f32 v17, v17, v21
    v_add_f32 v18, v18, v22
    v_add_f32 v19, v19, v23
    v_fmac_f32 v112, v96, v19
    v_fmac_f32 v113, v97, v18
    v_fmac_f32 v114, v98, v17
    v_fmac_f32 v115, v99, v16
    v_cvt_pk_bf16_f32 v72, v112, v113
    v_cvt_pk_bf16_f32 v73, v114, v115
    s_waitcnt lgkmcnt(4)
    v_add_f32 v24, v24, v28
    v_add_f32 v25, v25, v29
    v_add_f32 v26, v26, v30
    v_add_f32 v27, v27, v31
    v_fmac_f32 v116, v100, v27
    v_fmac_f32 v117, v101, v26
    v_fmac_f32 v118, v102, v25
    v_fmac_f32 v119, v103, v24
    v_cvt_pk_bf16_f32 v74, v116, v117
    v_cvt_pk_bf16_f32 v75, v118, v119
    buffer_store_dwordx4 v[72:75], v134, s[28:31], s53 offen offset:0 sc1
    s_waitcnt lgkmcnt(2)
    v_add_f32 v32, v32, v36
    v_add_f32 v33, v33, v37
    v_add_f32 v34, v34, v38
    v_add_f32 v35, v35, v39
    v_fmac_f32 v120, v104, v35
    v_fmac_f32 v121, v105, v34
    v_fmac_f32 v122, v106, v33
    v_fmac_f32 v123, v107, v32
    v_cvt_pk_bf16_f32 v76, v120, v121
    v_cvt_pk_bf16_f32 v77, v122, v123
    s_waitcnt lgkmcnt(0)
    v_add_f32 v40, v40, v44
    v_add_f32 v41, v41, v45
    v_add_f32 v42, v42, v46
    v_add_f32 v43, v43, v47
    v_fmac_f32 v124, v108, v43
    v_fmac_f32 v125, v109, v42
    v_fmac_f32 v126, v110, v41
    v_fmac_f32 v127, v111, v40
    v_cvt_pk_bf16_f32 v78, v124, v125
    v_cvt_pk_bf16_f32 v79, v126, v127
    buffer_store_dwordx4 v[76:79], v134, s[28:31], s53 offen offset:128 sc1
L_fu_entry:
    s_load_dwordx2 s[100:101], s[0:1], 80
    s_mov_b32 s19, s16
    s_mov_b32 s0, s3
    s_mov_b32 s62, 4000
    v_mov_b32 v31, s3
    v_lshlrev_b32 v4, 4, v1
    v_add_u32 v5, 4096, v4
    v_and_b32 v82, 48, v1
    s_mov_b32 s3, 0x3800
    s_mov_b32 s16, 0x7000
    s_mov_b32 s6, 0xa800
    s_mov_b32 s40, 0xe000
    s_mov_b32 s42, 0x11800
    s_mov_b32 s43, 0x15000
    s_barrier
    s_and_b32 s15, s2, 1
    s_lshl_b32 s15, s15, 3
    s_bfe_u32 s17, s2, 0x30003
    s_or_b32 s15, s15, s17
    s_bfe_u32 s14, s2, 0x20001
    s_lshl_b32 s14, s14, 2
    s_lshr_b32 s17, s2, 6
    s_or_b32 s14, s14, s17
    v_lshrrev_b32 v100, 3, v1
    v_and_b32 v101, 7, v1
    v_and_b32 v102, 6, v100
    v_xor_b32 v101, v101, v102
    v_lshlrev_b32 v100, 7, v100
    v_lshl_add_u32 v7, v101, 4, v100
    s_and_b32 s63, s19, 1
    s_lshr_b32 s64, s19, 1
    s_lshl_b32 s44, s64, 11
    s_mul_i32 s65, s63, 57344
    s_add_u32 s17, s65, s44
    s_mul_i32 s45, s63, 28672
    s_sub_u32 s18, s44, s45
    s_add_u32 s18, s18, 57344
    s_mul_i32 s46, s14, 114688
    s_add_u32 s46, s46, 0x380000
    s_mov_b32 s82, 114688
    s_mov_b32 s83, 0x00020000
    s_lshl_b32 s41, s15, 1
    s_add_u32 s41, s41, s64
    s_mov_b32 m0, s17
    s_waitcnt lgkmcnt(0)
    s_add_u32 s80, s12, s46
    s_addc_u32 s81, s13, 0
    s_add_u32 s7, s65, s45
    s_add_u32 s7, s7, s44
    v_lshrrev_b32 v101, 4, v1
    s_lshr_b32 s44, s15, 3
    s_lshl_b32 s57, s14, 1
    s_add_u32 s57, s57, s44
    s_and_b32 s58, s15, 7
    s_cmp_eq_u32 s58, 7
    s_cselect_b32 s46, 0, -1
    s_and_b32 s45, s58, s46
    s_lshl_b32 s45, s45, 13
    s_add_u32 s67, s45, 0
    s_cmp_ge_u32 s67, 28672
    s_cselect_b32 s47, 1, 0
    s_cmp_eq_u32 s47, s44
    s_addc_u32 s47, s47, 0
    s_mul_i32 s47, s47, 28672
    s_add_u32 s67, s67, s47
    s_add_u32 s68, s45, 2048
    s_cmp_ge_u32 s68, 28672
    s_cselect_b32 s47, 1, 0
    s_cmp_eq_u32 s47, s44
    s_addc_u32 s47, s47, 0
    s_mul_i32 s47, s47, 28672
    s_add_u32 s68, s68, s47
    s_add_u32 s69, s45, 4096
    s_cmp_ge_u32 s69, 28672
    s_cselect_b32 s47, 1, 0
    s_cmp_eq_u32 s47, s44
    s_addc_u32 s47, s47, 0
    s_mul_i32 s47, s47, 28672
    s_add_u32 s69, s69, s47
    s_add_u32 s75, s45, 6144
    s_cmp_ge_u32 s75, 28672
    s_cselect_b32 s47, 1, 0
    s_cmp_eq_u32 s47, s44
    s_addc_u32 s47, s47, 0
    s_mul_i32 s47, s47, 28672
    s_add_u32 s75, s75, s47
    s_mul_i32 s44, s19, 401408
    s_mul_i32 s45, s58, 28672
    s_add_u32 s44, s44, s45
    s_add_u32 s44, s44, 0x1400000
L_tf0:
    s_cbranch_execz L_tret
    s_add_u32 s28, s12, s44
    s_addc_u32 s29, s13, 0
    s_and_b32 s30, s46, 229376
    s_mov_b32 s31, 0x00020000
    s_mov_b32 s50, 7168
    s_mov_b32 s51, 14336
    s_mov_b32 s53, 200704
    s_mov_b32 s56, 222208
    s_lshl_b32 s59, s57, 2
    s_add_u32 s59, s59, s19
    s_mul_i32 s44, s57, 229376
    s_add_u32 s44, s44, 0x17e8000
    s_add_u32 s36, s12, s44
    s_addc_u32 s37, s13, 0
    s_and_b32 s38, s46, 327680
    s_mul_i32 s4, s19, 24576
    s_mul_i32 s5, s19, 57344
    s_mov_b32 s17, 0
    s_mul_i32 s44, s59, 14336
    s_lshl_b32 s45, s58, 7
    s_add_u32 s44, s44, s45
    s_add_u32 s100, s100, s44
    s_addc_u32 s101, s101, 0
    s_lshl_b32 s60, s14, 1
    s_add_u32 s60, s60, s63
    s_lshl_b32 s60, s60, 3
    s_lshr_b32 s44, s41, 2
    s_add_u32 s60, s60, s44
    s_lshr_b32 s44, s60, 1
    s_lshl_b32 s44, s44, 10
    s_and_b32 s45, s41, 7
    s_lshl_b32 s45, s45, 2
    s_add_u32 s60, s44, s45
    s_lshl_b32 s59, s59, 10
    v_lshrrev_b32 v102, 2, v1
    v_lshlrev_b32 v102, 7, v102
    v_bfe_u32 v103, v1, 3, 2
    v_lshl_add_u32 v102, v103, 5, v102
    v_and_b32 v103, 3, v1
    v_lshl_add_u32 v78, v103, 3, v102
    v_and_b32 v102, 15, v1
    v_lshlrev_b32 v80, 4, v102
    s_and_b32 s47, s19, 2
    v_xor_b32 v103, s47, v101
    v_lshl_add_u32 v79, v103, 10, v80
    s_waitcnt vmcnt(0)
    buffer_store_dword v31, v133, s[32:35], 0 offen sc1
    v_cmp_ne_u32 vcc, s0, v10
    s_cbranch_vccnz L_fu_w1
L_fu_w1b:
    buffer_load_dwordx4 v[140:143], v4, s[24:27], 0 offen offset:0
    s_and_b32 s48, s41, 3
    s_lshl_b32 s48, s48, 8
    s_add_u32 s49, s48, 0
    v_add_u32 v12, s49, v79
    s_add_u32 s49, s48, 4096
    buffer_load_dwordx4 v[144:147], v4, s[24:27], 0 offen offset:1024
    v_add_u32 v13, s49, v79
    s_add_u32 s49, s48, 8192
    v_add_u32 v14, s49, v79
    s_add_u32 s49, s48, 12288
    v_add_u32 v15, s49, v79
    buffer_load_dwordx4 v[148:151], v4, s[24:27], 0 offen offset:2048
    v_lshrrev_b32 v102, 2, v102
    v_cmp_eq_u32 vcc, v102, v101
    s_lshl_b32 s48, s63, 10
    s_lshl_b32 s49, s47, 8
    s_add_u32 s48, s48, s49
    buffer_load_dwordx4 v[152:155], v4, s[24:27], 0 offen offset:3072
    s_add_u32 s48, s48, 147456
    v_add_u32 v39, s48, v80
    v_lshrrev_b32 v103, 1, v4
    v_and_b32 v103, 0x1f0, v103
    v_add_u32 v103, 149504, v103
    buffer_load_dwordx4 v[156:159], v5, s[24:27], 0 offen offset:0
    v_cndmask_b32 v35, v103, v39, vcc
    s_lshl_b32 s48, s19, 12
    s_add_u32 s48, s48, 114688
    v_add_u32 v43, s48, v4
    v_xor_b32 v47, 4096, v43
    buffer_load_dwordx4 v[160:163], v5, s[24:27], 0 offen offset:1024
    v_add_u32 v81, s65, v78
    s_lshl_b32 s49, s19, 5
    v_xor_b32 v6, s49, v78
    s_xor_b32 s48, s47, 0
    s_lshl_b32 s49, s48, 5
    buffer_load_dwordx4 v[164:167], v5, s[24:27], 0 offen offset:2048
    v_xor_b32 v8, s49, v81
    s_add_u32 s48, s19, 0
    s_and_b32 s48, s48, 3
    s_lshl_b32 s49, s48, 10
    s_add_u32 s49, s49, 98304
    buffer_load_dwordx4 v[168:171], v4, s[24:27], s3 offen offset:0
    v_add_u32 v16, s49, v4
    s_xor_b32 s48, s47, 1
    s_lshl_b32 s49, s48, 5
    v_xor_b32 v9, s49, v81
    s_add_u32 s48, s19, 1
    buffer_load_dwordx4 v[172:175], v4, s[24:27], s3 offen offset:1024
    s_and_b32 s48, s48, 3
    s_lshl_b32 s49, s48, 10
    s_add_u32 s49, s49, 98304
    v_add_u32 v17, s49, v4
    s_xor_b32 s48, s47, 2
    buffer_load_dwordx4 v[176:179], v4, s[24:27], s3 offen offset:2048
    s_lshl_b32 s49, s48, 5
    v_xor_b32 v10, s49, v81
    s_add_u32 s48, s19, 2
    s_and_b32 s48, s48, 3
    s_lshl_b32 s49, s48, 10
    buffer_load_dwordx4 v[180:183], v4, s[24:27], s3 offen offset:3072
    s_add_u32 s49, s49, 98304
    v_add_u32 v18, s49, v4
    s_xor_b32 s48, s47, 3
    s_lshl_b32 s49, s48, 5
    v_xor_b32 v11, s49, v81
    buffer_load_dwordx4 v[184:187], v5, s[24:27], s3 offen offset:0
    s_add_u32 s48, s19, 3
    s_and_b32 s48, s48, 3
    s_lshl_b32 s49, s48, 10
    s_add_u32 s49, s49, 98304
    v_add_u32 v19, s49, v4
    buffer_load_dwordx4 v[188:191], v5, s[24:27], s3 offen offset:1024
    v_mov_b32 v20, 0x3f803f80
    v_mov_b32 v88, -1
    v_mov_b32 v21, 0x3f803f80
    v_mov_b32 v89, -1
    v_mov_b32 v22, 0x3f803f80
    buffer_load_dwordx4 v[192:195], v5, s[24:27], s3 offen offset:2048
    v_mov_b32 v90, -1
    v_mov_b32 v23, 0x3f803f80
    v_mov_b32 v91, -1
    s_mov_b32 s66, 16384
    s_mov_b32 s8, 0x22222222
    buffer_load_dwordx4 v[196:199], v4, s[24:27], s16 offen offset:0
    s_mov_b32 s9, 0x22222222
    s_mov_b32 s10, 0x44444444
    s_mov_b32 s11, 0x44444444
    s_mov_b32 s70, 0x88888888
    s_mov_b32 s71, 0x88888888
    buffer_load_dwordx4 v[200:203], v4, s[24:27], s16 offen offset:1024
    s_lshr_b32 s44, s14, 2
    s_lshl_b32 s44, s44, 2
    s_add_u32 s44, s44, s19
    s_and_b32 s45, s15, 15
    s_lshl_b32 s45, s45, 4
    buffer_load_dwordx4 v[204:207], v4, s[24:27], s16 offen offset:2048
    s_add_u32 s44, s44, s45
    s_mul_i32 s44, s44, 448
    s_add_u32 s44, s44, 0x24000
    v_lshl_add_u32 v104, v1, 3, s44
    s_mul_i32 s44, s41, 7
    buffer_load_dwordx4 v[208:211], v4, s[24:27], s16 offen offset:3072
    v_and_b32 v105, 1, v1
    v_mad_u32_u24 v105, v105, 6, s44
    v_lshrrev_b32 v105, 3, v105
    s_and_b32 s44, s2, 3
    s_lshl_b32 s44, s44, 12
    buffer_load_dwordx4 v[212:215], v5, s[24:27], s16 offen offset:0
    s_add_u32 s44, s44, 0x20070
    v_lshl_add_u32 v105, v105, 7, s44
    v_cmp_gt_u32 vcc, 56, v1
    s_nop 1
    v_cndmask_b32 v104, v105, v104, vcc
    buffer_load_dwordx4 v[216:219], v5, s[24:27], s16 offen offset:1024
    buffer_load_dwordx4 v[220:223], v5, s[24:27], s16 offen offset:2048
    buffer_load_dword v105, v104, s[32:35], 0 offen sc1
    s_mov_b32 s39, 0x00020000
    s_mov_b32 s52, 21504
    s_mov_b32 s54, 207872
    s_mov_b32 s55, 215040
    s_branch L_fu_hw
L_fu_hp:
    buffer_load_dword v105, v104, s[32:35], 0 offen sc1
L_fu_hw:
    s_sub_u32 s62, s62, 1
    s_cbranch_scc1 L_ff_end
    s_waitcnt vmcnt(0)
    v_cmp_ne_u32 vcc, s0, v105
    s_cbranch_vccz L_fu_hg
    s_mov_b64 exec, vcc
    s_sleep 6
    s_branch L_fu_hp
L_fu_hg:
    s_mov_b64 exec, -1
    buffer_load_dwordx4 v7, s[80:83], s18 offen offset:0 lds
    buffer_load_dwordx4 v7, s[80:83], s18 offen offset:1024 lds
    s_add_u32 m0, m0, 4096
    s_add_u32 s18, s18, 4096
    buffer_load_dwordx4 v7, s[80:83], s18 offen offset:0 lds
    buffer_load_dwordx4 v7, s[80:83], s18 offen offset:1024 lds
    s_add_u32 m0, m0, 4096
    s_add_u32 s18, s18, 4096
    buffer_load_dwordx4 v7, s[80:83], s18 offen offset:0 lds
L_tf1:
    s_cbranch_execz L_tret
    buffer_load_dwordx4 v7, s[80:83], s18 offen offset:1024 lds
    s_add_u32 m0, m0, 4096
    s_add_u32 s18, s18, 4096
    buffer_load_dwordx4 v7, s[80:83], s18 offen offset:0 lds
    buffer_load_dwordx4 v7, s[80:83], s18 offen offset:1024 lds
    s_add_u32 m0, m0, 4096
    s_add_u32 s18, s18, 4096
    buffer_load_dwordx4 v7, s[80:83], s18 offen offset:0 lds
    buffer_load_dwordx4 v7, s[80:83], s18 offen offset:1024 lds
    s_add_u32 m0, m0, 4096
    s_add_u32 s18, s18, 4096
    buffer_load_dwordx4 v7, s[80:83], s18 offen offset:0 lds
    buffer_load_dwordx4 v7, s[80:83], s18 offen offset:1024 lds
    s_add_u32 m0, m0, 4096
    s_add_u32 s18, s18, 4096
    buffer_load_dwordx4 v7, s[80:83], s18 offen offset:0 lds
    buffer_load_dwordx4 v7, s[80:83], s18 offen offset:1024 lds
    s_add_u32 m0, m0, 4096
    s_mov_b32 s18, s7
    buffer_load_dwordx4 v7, s[80:83], s18 offen offset:0 lds
    buffer_load_dwordx4 v7, s[80:83], s18 offen offset:1024 lds
    s_add_u32 m0, m0, 4096
    s_add_u32 s18, s18, 4096
    buffer_load_dwordx4 v7, s[80:83], s18 offen offset:0 lds
    buffer_load_dwordx4 v7, s[80:83], s18 offen offset:1024 lds
    s_add_u32 m0, m0, 4096
    s_add_u32 s18, s18, 4096
    buffer_load_dwordx4 v7, s[80:83], s18 offen offset:0 lds
    buffer_load_dwordx4 v7, s[80:83], s18 offen offset:1024 lds
    s_add_u32 m0, m0, 4096
    s_add_u32 s18, s18, 4096
    buffer_load_dwordx4 v7, s[80:83], s18 offen offset:0 lds
    buffer_load_dwordx4 v7, s[80:83], s18 offen offset:1024 lds
    s_add_u32 m0, m0, 4096
    s_add_u32 s18, s18, 4096
    buffer_load_dwordx4 v7, s[80:83], s18 offen offset:0 lds
    buffer_load_dwordx4 v7, s[80:83], s18 offen offset:1024 lds
    s_add_u32 m0, m0, 4096
    s_add_u32 s18, s18, 4096
    buffer_load_dwordx4 v7, s[80:83], s18 offen offset:0 lds
    buffer_load_dwordx4 v7, s[80:83], s18 offen offset:1024 lds
    s_add_u32 m0, m0, 4096
    s_add_u32 s18, s18, 4096
    buffer_load_dwordx4 v7, s[80:83], s18 offen offset:0 lds
    buffer_load_dwordx4 v7, s[80:83], s18 offen offset:1024 lds
    s_waitcnt vmcnt(24)
    s_barrier
    ds_read_b64_tr_b16 a[0:1], v8 offset:0
    ds_read_b64_tr_b16 a[2:3], v8 offset:2048
    ds_read_b64_tr_b16 a[4:5], v9 offset:0
    ds_read_b64_tr_b16 a[6:7], v9 offset:2048
    ds_read_b64_tr_b16 a[32:33], v8 offset:4096
    ds_read_b64_tr_b16 a[34:35], v8 offset:6144
    ds_read_b64_tr_b16 a[36:37], v9 offset:4096
    ds_read_b64_tr_b16 a[38:39], v9 offset:6144
    ds_read_b64_tr_b16 a[8:9], v10 offset:0
    ds_read_b64_tr_b16 a[10:11], v10 offset:2048
    ds_read_b64_tr_b16 a[12:13], v11 offset:0
    ds_read_b64_tr_b16 a[14:15], v11 offset:2048
    ds_read_b64_tr_b16 a[40:41], v10 offset:4096
    ds_read_b64_tr_b16 a[42:43], v10 offset:6144
    s_waitcnt lgkmcnt(12)
    v_mfma_f32_16x16x32_bf16 v[92:95], v[20:23], a[0:3], 0
    buffer_load_dwordx4 v[48:51], v82, s[76:79], 0 offen offset:0 sc1
    ds_read_b64_tr_b16 a[44:45], v11 offset:4096
    ds_read_b64_tr_b16 a[46:47], v11 offset:6144
    v_mfma_f32_16x16x32_bf16 v[96:99], a[0:3], a[0:3], 0
    s_waitcnt lgkmcnt(12)
    v_mfma_f32_16x16x32_bf16 v[100:103], v[20:23], a[4:7], 0
    s_waitcnt vmcnt(15)
    s_barrier
    buffer_load_dwordx4 v[52:55], v82, s[76:79], 0 offen offset:64 sc1
    v_mfma_f32_16x16x32_bf16 v[104:107], a[4:7], a[4:7], 0
    ds_read_b64_tr_b16 a[64:65], v8 offset:8192
    ds_read_b64_tr_b16 a[66:67], v8 offset:10240
    s_waitcnt lgkmcnt(12)
    v_mfma_f32_16x16x32_bf16 v[92:95], v[20:23], a[32:35], v[92:95]
    buffer_load_dwordx4 v[56:59], v82, s[76:79], 0 offen offset:128 sc1
    ds_read_b64_tr_b16 a[68:69], v9 offset:8192
    ds_read_b64_tr_b16 a[70:71], v9 offset:10240
    v_mfma_f32_16x16x32_bf16 v[96:99], a[32:35], a[32:35], v[96:99]
    ds_read_b64_tr_b16 a[96:97], v8 offset:12288
    ds_read_b64_tr_b16 a[98:99], v8 offset:14336
    s_waitcnt lgkmcnt(14)
    v_mfma_f32_16x16x32_bf16 v[100:103], v[20:23], a[36:39], v[100:103]
    buffer_load_dwordx4 v[60:63], v82, s[76:79], 0 offen offset:192 sc1
    ds_read_b64_tr_b16 a[100:101], v9 offset:12288
    ds_read_b64_tr_b16 a[102:103], v9 offset:14336
    v_mfma_f32_16x16x32_bf16 v[104:107], a[36:39], a[36:39], v[104:107]
    ds_read_b64_tr_b16 a[128:129], v8 offset:16384
    ds_read_b64_tr_b16 a[130:131], v8 offset:18432
    s_waitcnt lgkmcnt(8)
    v_mfma_f32_16x16x32_bf16 v[92:95], v[20:23], a[64:67], v[92:95]
    buffer_store_dwordx4 v[88:91], v13, s[20:23], 0 offen sc1
    ds_read_b64_tr_b16 a[132:133], v9 offset:16384
    ds_read_b64_tr_b16 a[134:135], v9 offset:18432
    v_mfma_f32_16x16x32_bf16 v[96:99], a[64:67], a[64:67], v[96:99]
    ds_read_b64_tr_b16 a[160:161], v8 offset:20480
    ds_read_b64_tr_b16 a[162:163], v8 offset:22528
    s_waitcnt lgkmcnt(10)
    v_mfma_f32_16x16x32_bf16 v[100:103], v[20:23], a[68:71], v[100:103]
    ds_read_b64_tr_b16 a[164:165], v9 offset:20480
    ds_read_b64_tr_b16 a[166:167], v9 offset:22528
    ds_read_b64_tr_b16 a[192:193], v8 offset:24576
    v_mfma_f32_16x16x32_bf16 v[104:107], a[68:71], a[68:71], v[104:107]
    ds_read_b64_tr_b16 a[194:195], v8 offset:26624
    ds_read_b64_tr_b16 a[196:197], v9 offset:24576
    s_waitcnt lgkmcnt(13)
    v_mfma_f32_16x16x32_bf16 v[92:95], v[20:23], a[96:99], v[92:95]
    buffer_load_dwordx4 v[64:67], v82, s[76:79], 0 offen offset:256 sc1
    ds_read_b64_tr_b16 a[198:199], v9 offset:26624
    ds_read_b64_tr_b16 a[72:73], v10 offset:8192
    v_mfma_f32_16x16x32_bf16 v[96:99], a[96:99], a[96:99], v[96:99]
    ds_read_b64_tr_b16 a[74:75], v10 offset:10240
    ds_read_b64_tr_b16 a[76:77], v11 offset:8192
    s_waitcnt lgkmcnt(14)
    v_mfma_f32_16x16x32_bf16 v[100:103], v[20:23], a[100:103], v[100:103]
    buffer_load_dwordx4 v[68:71], v82, s[76:79], 0 offen offset:320 sc1
    ds_read_b64_tr_b16 a[78:79], v11 offset:10240
    ds_read_b64_tr_b16 a[104:105], v10 offset:12288
    v_mfma_f32_16x16x32_bf16 v[104:107], a[100:103], a[100:103], v[104:107]
    ds_read_b64_tr_b16 a[106:107], v10 offset:14336
    ds_read_b64_tr_b16 a[108:109], v11 offset:12288
    s_waitcnt lgkmcnt(14)
    v_mfma_f32_16x16x32_bf16 v[92:95], v[20:23], a[128:131], v[92:95]
    buffer_load_dwordx4 v[72:75], v82, s[76:79], 0 offen offset:384 sc1
    ds_read_b64_tr_b16 a[110:111], v11 offset:14336
    ds_read_b64_tr_b16 a[136:137], v10 offset:16384
    v_mfma_f32_16x16x32_bf16 v[96:99], a[128:131], a[128:131], v[96:99]
    ds_read_b64_tr_b16 a[138:139], v10 offset:18432
    ds_read_b64_tr_b16 a[140:141], v11 offset:16384
    v_mfma_f32_16x16x32_bf16 v[100:103], v[20:23], a[132:135], v[100:103]
    buffer_load_dwordx4 v[224:227], v4, s[24:27], s6 offen offset:0
    ds_read_b64_tr_b16 a[142:143], v11 offset:18432
    ds_read_b64_tr_b16 a[168:169], v10 offset:20480
    v_mfma_f32_16x16x32_bf16 v[104:107], a[132:135], a[132:135], v[104:107]
    ds_read_b64_tr_b16 a[170:171], v10 offset:22528
    ds_read_b64_tr_b16 a[172:173], v11 offset:20480
    s_waitcnt lgkmcnt(14)
    v_mfma_f32_16x16x32_bf16 v[92:95], v[20:23], a[160:163], v[92:95]
    buffer_load_dwordx4 v[228:231], v4, s[24:27], s6 offen offset:1024
    ds_read_b64_tr_b16 a[174:175], v11 offset:22528
    ds_read_b64_tr_b16 a[200:201], v10 offset:24576
    v_mfma_f32_16x16x32_bf16 v[96:99], a[160:163], a[160:163], v[96:99]
    ds_read_b64_tr_b16 a[202:203], v10 offset:26624
    ds_read_b64_tr_b16 a[204:205], v11 offset:24576
    v_mfma_f32_16x16x32_bf16 v[100:103], v[20:23], a[164:167], v[100:103]
    buffer_load_dwordx4 v[232:235], v4, s[24:27], s6 offen offset:2048
    ds_read_b64_tr_b16 a[206:207], v11 offset:26624
    v_mfma_f32_16x16x32_bf16 v[104:107], a[164:167], a[164:167], v[104:107]
L_tf2:
    s_cbranch_execz L_tret
    v_mfma_f32_16x16x32_bf16 v[92:95], v[20:23], a[192:195], v[92:95]
    buffer_load_dwordx4 v[236:239], v4, s[24:27], s6 offen offset:3072
    v_mfma_f32_16x16x32_bf16 v[96:99], a[192:195], a[192:195], v[96:99]
    v_mfma_f32_16x16x32_bf16 v[100:103], v[20:23], a[196:199], v[100:103]
    buffer_store_dwordx4 v[88:91], v14, s[20:23], 0 offen sc1
    v_mfma_f32_16x16x32_bf16 v[104:107], a[196:199], a[196:199], v[104:107]
    s_nop 2
    ds_write_b128 v43, v[92:95] offset:16384
    s_nop 0
    ds_write_b128 v43, v[96:99] offset:17408
    ds_write_b128 v43, v[100:103] offset:18432
    s_nop 0
    ds_write_b128 v43, v[104:107] offset:19456
    s_waitcnt vmcnt(19)
    s_waitcnt lgkmcnt(0)
    s_barrier
    ds_read_b128 v[108:111], v47 offset:16384
    ds_read_b128 v[112:115], v47 offset:17408
    ds_read_b128 v[116:119], v47 offset:18432
    ds_read_b128 v[120:123], v47 offset:19456
    ds_read_b64_tr_b16 a[16:17], v8 offset:28672
    ds_read_b64_tr_b16 a[18:19], v8 offset:30720
    ds_read_b64_tr_b16 a[20:21], v9 offset:28672
    ds_read_b64_tr_b16 a[22:23], v9 offset:30720
    ds_read_b64_tr_b16 a[48:49], v8 offset:32768
    ds_read_b64_tr_b16 a[50:51], v8 offset:34816
    ds_read_b64_tr_b16 a[52:53], v9 offset:32768
    ds_read_b64_tr_b16 a[54:55], v9 offset:34816
    s_waitcnt lgkmcnt(6)
    v_mfma_f32_16x16x32_bf16 v[108:111], v[20:23], a[16:19], v[108:111]
    ds_read_b64_tr_b16 a[80:81], v8 offset:36864
    ds_read_b64_tr_b16 a[82:83], v8 offset:38912
    ds_read_b64_tr_b16 a[84:85], v9 offset:36864
    v_mfma_f32_16x16x32_bf16 v[112:115], a[16:19], a[16:19], v[112:115]
    ds_read_b64_tr_b16 a[86:87], v9 offset:38912
    ds_read_b64_tr_b16 a[112:113], v8 offset:40960
    s_waitcnt lgkmcnt(9)
    v_mfma_f32_16x16x32_bf16 v[116:119], v[20:23], a[20:23], v[116:119]
    buffer_load_dwordx4 v[240:243], v5, s[24:27], s6 offen offset:0
    ds_read_b64_tr_b16 a[114:115], v8 offset:43008
    ds_read_b64_tr_b16 a[116:117], v9 offset:40960
    v_mfma_f32_16x16x32_bf16 v[120:123], a[20:23], a[20:23], v[120:123]
    ds_read_b64_tr_b16 a[118:119], v9 offset:43008
    ds_read_b64_tr_b16 a[24:25], v10 offset:28672
    s_waitcnt lgkmcnt(11)
    v_mfma_f32_16x16x32_bf16 v[108:111], v[20:23], a[48:51], v[108:111]
    buffer_load_dwordx4 v[244:247], v5, s[24:27], s6 offen offset:1024
    ds_read_b64_tr_b16 a[26:27], v10 offset:30720
    ds_read_b64_tr_b16 a[28:29], v11 offset:28672
    v_mfma_f32_16x16x32_bf16 v[112:115], a[48:51], a[48:51], v[112:115]
    ds_read_b64_tr_b16 a[30:31], v11 offset:30720
    ds_read_b64_tr_b16 a[56:57], v10 offset:32768
    s_waitcnt lgkmcnt(13)
    v_mfma_f32_16x16x32_bf16 v[116:119], v[20:23], a[52:55], v[116:119]
    s_waitcnt vmcnt(15)
    s_barrier
    buffer_load_dwordx4 v[248:251], v5, s[24:27], s6 offen offset:2048
    v_mfma_f32_16x16x32_bf16 v[120:123], a[52:55], a[52:55], v[120:123]
    ds_read_b64_tr_b16 a[58:59], v10 offset:34816
    ds_read_b64_tr_b16 a[60:61], v11 offset:32768
    s_waitcnt lgkmcnt(13)
    v_mfma_f32_16x16x32_bf16 v[108:111], v[20:23], a[80:83], v[108:111]
    ds_read_b64_tr_b16 a[62:63], v11 offset:34816
    ds_read_b64_tr_b16 a[144:145], v8 offset:45056
    ds_read_b64_tr_b16 a[146:147], v8 offset:47104
    v_mfma_f32_16x16x32_bf16 v[112:115], a[80:83], a[80:83], v[112:115]
    ds_read_b64_tr_b16 a[148:149], v9 offset:45056
    ds_read_b64_tr_b16 a[150:151], v9 offset:47104
    s_waitcnt lgkmcnt(14)
    v_mfma_f32_16x16x32_bf16 v[116:119], v[20:23], a[84:87], v[116:119]
    ds_read_b64_tr_b16 a[176:177], v8 offset:49152
    ds_read_b64_tr_b16 a[178:179], v8 offset:51200
    ds_read_b64_tr_b16 a[180:181], v9 offset:49152
    v_mfma_f32_16x16x32_bf16 v[120:123], a[84:87], a[84:87], v[120:123]
    ds_read_b64_tr_b16 a[182:183], v9 offset:51200
    ds_read_b64_tr_b16 a[208:209], v8 offset:53248
    v_mfma_f32_16x16x32_bf16 v[108:111], v[20:23], a[112:115], v[108:111]
    ds_read_b64_tr_b16 a[210:211], v8 offset:55296
    ds_read_b64_tr_b16 a[212:213], v9 offset:53248
    ds_read_b64_tr_b16 a[214:215], v9 offset:55296
    v_mfma_f32_16x16x32_bf16 v[112:115], a[112:115], a[112:115], v[112:115]
    ds_read_b64_tr_b16 a[88:89], v10 offset:36864
    ds_read_b64_tr_b16 a[90:91], v10 offset:38912
    s_waitcnt lgkmcnt(14)
    v_mfma_f32_16x16x32_bf16 v[116:119], v[20:23], a[116:119], v[116:119]
    ds_read_b64_tr_b16 a[92:93], v11 offset:36864
    ds_read_b64_tr_b16 a[94:95], v11 offset:38912
    ds_read_b64_tr_b16 a[120:121], v10 offset:40960
    v_mfma_f32_16x16x32_bf16 v[120:123], a[116:119], a[116:119], v[120:123]
    ds_read_b64_tr_b16 a[122:123], v10 offset:43008
    ds_read_b64_tr_b16 a[124:125], v11 offset:40960
    s_waitcnt lgkmcnt(14)
    v_mfma_f32_16x16x32_bf16 v[108:111], v[20:23], a[144:147], v[108:111]
    buffer_store_dwordx4 v[88:91], v15, s[20:23], 0 offen sc1
    ds_read_b64_tr_b16 a[126:127], v11 offset:43008
    ds_read_b64_tr_b16 a[152:153], v10 offset:45056
    v_mfma_f32_16x16x32_bf16 v[112:115], a[144:147], a[144:147], v[112:115]
    ds_read_b64_tr_b16 a[154:155], v10 offset:47104
    ds_read_b64_tr_b16 a[156:157], v11 offset:45056
    v_mfma_f32_16x16x32_bf16 v[116:119], v[20:23], a[148:151], v[116:119]
    ds_read_b64_tr_b16 a[158:159], v11 offset:47104
    ds_read_b64_tr_b16 a[184:185], v10 offset:49152
    ds_read_b64_tr_b16 a[186:187], v10 offset:51200
    v_mfma_f32_16x16x32_bf16 v[120:123], a[148:151], a[148:151], v[120:123]
    ds_read_b64_tr_b16 a[188:189], v11 offset:49152
    ds_read_b64_tr_b16 a[190:191], v11 offset:51200
    s_waitcnt lgkmcnt(14)
    v_mfma_f32_16x16x32_bf16 v[108:111], v[20:23], a[176:179], v[108:111]
    ds_read_b64_tr_b16 a[216:217], v10 offset:53248
    ds_read_b64_tr_b16 a[218:219], v10 offset:55296
    ds_read_b64_tr_b16 a[220:221], v11 offset:53248
    v_mfma_f32_16x16x32_bf16 v[112:115], a[176:179], a[176:179], v[112:115]
    ds_read_b64_tr_b16 a[222:223], v11 offset:55296
    v_add_u32 v24, s67, v6
    v_mfma_f32_16x16x32_bf16 v[116:119], v[20:23], a[180:183], v[116:119]
    v_add_u32 v26, s68, v6
    v_add_u32 v8, s69, v6
    v_add_u32 v10, s75, v6
    v_mfma_f32_16x16x32_bf16 v[120:123], a[180:183], a[180:183], v[120:123]
    ds_read_b64_tr_b16 v[24:25], v24
    ds_read_b64_tr_b16 v[26:27], v26
    v_mfma_f32_16x16x32_bf16 v[108:111], v[20:23], a[208:211], v[108:111]
    ds_read_b64_tr_b16 v[8:9], v8
    ds_read_b64_tr_b16 v[10:11], v10
    v_mfma_f32_16x16x32_bf16 v[112:115], a[208:211], a[208:211], v[112:115]
    v_mfma_f32_16x16x32_bf16 v[116:119], v[20:23], a[212:215], v[116:119]
    v_mfma_f32_16x16x32_bf16 v[120:123], a[212:215], a[212:215], v[120:123]
    v_mfma_f32_16x16x32_bf16 v[124:127], v[140:143], a[0:3], 0
    v_mfma_f32_16x16x32_bf16 v[128:131], v[140:143], a[4:7], 0
    v_mfma_f32_16x16x32_bf16 v[132:135], v[140:143], a[8:11], 0
    v_mfma_f32_16x16x32_bf16 v[136:139], v[140:143], a[12:15], 0
    s_nop 1
    v_cndmask_b32 v77, v112, v113, s[8:9]
    s_nop 0
    v_cndmask_b32 v79, v120, v121, s[8:9]
    v_mfma_f32_16x16x32_bf16 v[124:127], v[144:147], a[32:35], v[124:127]
    v_mul_f32 v76, 0x3b124925, v108
    v_mul_f32 v78, 0x3b124925, v116
    v_cndmask_b32 v77, v77, v114, s[10:11]
    v_mfma_f32_16x16x32_bf16 v[128:131], v[144:147], a[36:39], v[128:131]
L_tf3:
    s_cbranch_execz L_tret
    v_cndmask_b32 v79, v79, v122, s[10:11]
    v_cvt_pk_bf16_f32 v32, -v76, -v76
    v_cvt_pk_bf16_f32 v36, -v78, -v78
    v_mfma_f32_16x16x32_bf16 v[132:135], v[144:147], a[40:43], v[132:135]
    buffer_store_dwordx4 v[88:91], v12, s[20:23], s66 offen sc1
    v_cndmask_b32 v77, v77, v115, s[70:71]
    v_cndmask_b32 v79, v79, v123, s[70:71]
    v_mfma_f32_16x16x32_bf16 v[136:139], v[144:147], a[44:47], v[136:139]
    v_lshlrev_b32 v32, 16, v32
    v_lshlrev_b32 v36, 16, v36
    v_mfma_f32_16x16x32_bf16 v[124:127], v[148:151], a[64:67], v[124:127]
    v_mul_f32 v77, 0x3b124925, v77
    v_mul_f32 v79, 0x3b124925, v79
    v_xor_b32 v80, 512, v39
    v_mfma_f32_16x16x32_bf16 v[128:131], v[148:151], a[68:71], v[128:131]
    v_fma_f32 v77, -v76, v76, v77
    v_fma_f32 v79, -v78, v78, v79
    v_and_b32 v29, 7, v1
    v_mfma_f32_16x16x32_bf16 v[132:135], v[148:151], a[72:75], v[132:135]
    v_max_f32 v77, 0, v77
    v_max_f32 v79, 0, v79
    v_lshlrev_b32 v28, 20, v1
    v_mfma_f32_16x16x32_bf16 v[136:139], v[148:151], a[76:79], v[136:139]
    v_cvt_pk_bf16_f32 v77, v77, v77
    v_cvt_pk_bf16_f32 v79, v79, v79
    v_mfma_f32_16x16x32_bf16 v[124:127], v[152:155], a[96:99], v[124:127]
    v_lshlrev_b32 v77, 16, v77
    v_lshlrev_b32 v79, 16, v79
    v_lshl_add_u32 v29, v29, 2, s59
    v_mfma_f32_16x16x32_bf16 v[128:131], v[152:155], a[100:103], v[128:131]
    v_add_f32 v77, 0x3727c5ac, v77
    v_add_f32 v79, 0x3727c5ac, v79
    v_add_u32 v28, s60, v28
    v_mfma_f32_16x16x32_bf16 v[132:135], v[152:155], a[104:107], v[132:135]
    buffer_load_dwordx4 a[252:255], v4, s[28:31], 0 offen offset:0
    v_cvt_pk_bf16_f32 v77, v77, v77
    v_cvt_pk_bf16_f32 v79, v79, v79
    v_mfma_f32_16x16x32_bf16 v[136:139], v[152:155], a[108:111], v[136:139]
    v_lshlrev_b32 v77, 16, v77
    v_lshlrev_b32 v79, 16, v79
    v_mfma_f32_16x16x32_bf16 v[124:127], v[156:159], a[128:131], v[124:127]
    buffer_load_dwordx4 a[248:251], v4, s[28:31], s50 offen offset:0
    v_sqrt_f32 v77, v77
    v_mfma_f32_16x16x32_bf16 v[128:131], v[156:159], a[132:135], v[128:131]
    v_sqrt_f32 v79, v79
    v_cvt_pk_bf16_f32 v77, v77, v77
    v_mfma_f32_16x16x32_bf16 v[132:135], v[156:159], a[136:139], v[132:135]
    v_cvt_pk_bf16_f32 v79, v79, v79
    v_lshlrev_b32 v77, 16, v77
    v_mfma_f32_16x16x32_bf16 v[136:139], v[156:159], a[140:143], v[136:139]
    v_lshlrev_b32 v79, 16, v79
    v_mul_f32 v34, v77, v77
    v_mfma_f32_16x16x32_bf16 v[124:127], v[160:163], a[160:163], v[124:127]
    buffer_load_dwordx4 a[244:247], v4, s[28:31], s51 offen offset:0
    v_rcp_f32 v33, v77
    v_mfma_f32_16x16x32_bf16 v[128:131], v[160:163], a[164:167], v[128:131]
    v_rcp_f32 v37, v79
    v_mul_f32 v38, v79, v79
    v_mfma_f32_16x16x32_bf16 v[132:135], v[160:163], a[168:171], v[132:135]
    v_mul_f32 v33, 0xbfb8aa3b, v33
    v_mul_f32 v37, 0xbfb8aa3b, v37
    v_mfma_f32_16x16x32_bf16 v[136:139], v[160:163], a[172:175], v[136:139]
    ds_write_b96 v35, v[32:34] offset:0
    ds_write_b96 v35, v[36:38] offset:256
    v_mfma_f32_16x16x32_bf16 v[124:127], v[164:167], a[192:195], v[124:127]
    buffer_store_dwordx4 v[88:91], v13, s[20:23], s66 offen sc1
    v_mfma_f32_16x16x32_bf16 v[128:131], v[164:167], a[196:199], v[128:131]
    v_mfma_f32_16x16x32_bf16 v[132:135], v[164:167], a[200:203], v[132:135]
    v_mfma_f32_16x16x32_bf16 v[136:139], v[164:167], a[204:207], v[136:139]
    v_mfma_f32_16x16x32_bf16 v[92:95], v[168:171], a[0:3], 0
    v_mfma_f32_16x16x32_bf16 v[96:99], v[168:171], a[4:7], 0
    v_mfma_f32_16x16x32_bf16 v[100:103], v[168:171], a[8:11], 0
    s_nop 0
    ds_write_b128 v43, v[124:127] offset:0
    buffer_load_dwordx4 a[240:243], v4, s[28:31], s52 offen offset:0
    v_mfma_f32_16x16x32_bf16 v[104:107], v[168:171], a[12:15], 0
    v_mfma_f32_16x16x32_bf16 v[92:95], v[172:175], a[32:35], v[92:95]
    v_mfma_f32_16x16x32_bf16 v[96:99], v[172:175], a[36:39], v[96:99]
    buffer_load_dwordx4 a[236:239], v4, s[28:31], s53 offen offset:0
    v_mfma_f32_16x16x32_bf16 v[100:103], v[172:175], a[40:43], v[100:103]
    ds_write_b128 v43, v[128:131] offset:1024
    v_mfma_f32_16x16x32_bf16 v[104:107], v[172:175], a[44:47], v[104:107]
L_tf4:
    s_cbranch_execz L_tret
    v_mfma_f32_16x16x32_bf16 v[92:95], v[176:179], a[64:67], v[92:95]
    v_mfma_f32_16x16x32_bf16 v[96:99], v[176:179], a[68:71], v[96:99]
    buffer_load_dwordx4 a[232:235], v4, s[28:31], s54 offen offset:0
    v_mfma_f32_16x16x32_bf16 v[100:103], v[176:179], a[72:75], v[100:103]
    ds_write_b128 v43, v[132:135] offset:2048
    v_mfma_f32_16x16x32_bf16 v[104:107], v[176:179], a[76:79], v[104:107]
    v_mfma_f32_16x16x32_bf16 v[92:95], v[180:183], a[96:99], v[92:95]
    buffer_load_dwordx4 a[228:231], v4, s[28:31], s55 offen offset:0
    v_mfma_f32_16x16x32_bf16 v[96:99], v[180:183], a[100:103], v[96:99]
    v_mfma_f32_16x16x32_bf16 v[100:103], v[180:183], a[104:107], v[100:103]
    ds_write_b128 v43, v[136:139] offset:3072
    buffer_store_dwordx4 v[88:91], v14, s[20:23], s66 offen sc1
    v_mfma_f32_16x16x32_bf16 v[104:107], v[180:183], a[108:111], v[104:107]
    v_mfma_f32_16x16x32_bf16 v[92:95], v[184:187], a[128:131], v[92:95]
    v_mfma_f32_16x16x32_bf16 v[96:99], v[184:187], a[132:135], v[96:99]
    v_mfma_f32_16x16x32_bf16 v[100:103], v[184:187], a[136:139], v[100:103]
    v_mfma_f32_16x16x32_bf16 v[104:107], v[184:187], a[140:143], v[104:107]
    v_mfma_f32_16x16x32_bf16 v[92:95], v[188:191], a[160:163], v[92:95]
    s_waitcnt lgkmcnt(0)
    s_barrier
    v_mfma_f32_16x16x32_bf16 v[96:99], v[188:191], a[164:167], v[96:99]
    ds_read_b128 v[108:111], v47 offset:0
    ds_read_b96 v[32:34], v39 offset:0
    v_mfma_f32_16x16x32_bf16 v[100:103], v[188:191], a[168:171], v[100:103]
    ds_read_b128 v[112:115], v47 offset:1024
    ds_read_b96 v[36:38], v39 offset:256
    v_mfma_f32_16x16x32_bf16 v[104:107], v[188:191], a[172:175], v[104:107]
    ds_read_b128 v[116:119], v47 offset:2048
    v_mfma_f32_16x16x32_bf16 v[92:95], v[192:195], a[192:195], v[92:95]
    ds_read_b128 v[120:123], v47 offset:3072
    s_add_u32 m0, s4, 0
    s_nop 0
    buffer_load_dwordx4 v5, s[28:31], 0 offen offset:0 lds
    v_mfma_f32_16x16x32_bf16 v[96:99], v[192:195], a[196:199], v[96:99]
    ds_read_b96 v[40:42], v80 offset:0
    ds_read_b96 v[44:46], v80 offset:256
    v_mfma_f32_16x16x32_bf16 v[100:103], v[192:195], a[200:203], v[100:103]
    buffer_load_dwordx4 v5, s[28:31], 0 offen offset:1024 lds
    v_add_u32 v7, 0xc000, v4
    v_mfma_f32_16x16x32_bf16 v[104:107], v[192:195], a[204:207], v[104:107]
    s_waitcnt lgkmcnt(2)
    v_mfma_f32_16x16x32_bf16 v[108:111], v[140:143], a[16:19], v[108:111]
    v_mfma_f32_16x16x32_bf16 v[112:115], v[140:143], a[20:23], v[112:115]
    v_mfma_f32_16x16x32_bf16 v[116:119], v[140:143], a[24:27], v[116:119]
    ds_write_b128 v43, v[92:95] offset:16384
    v_mfma_f32_16x16x32_bf16 v[120:123], v[140:143], a[28:31], v[120:123]
    v_mfma_f32_16x16x32_bf16 v[108:111], v[144:147], a[48:51], v[108:111]
    buffer_load_dwordx4 v[140:143], v4, s[24:27], s40 offen offset:0
    v_mfma_f32_16x16x32_bf16 v[112:115], v[144:147], a[52:55], v[112:115]
    v_mfma_f32_16x16x32_bf16 v[116:119], v[144:147], a[56:59], v[116:119]
    ds_write_b128 v43, v[96:99] offset:17408
    v_mfma_f32_16x16x32_bf16 v[120:123], v[144:147], a[60:63], v[120:123]
    v_mfma_f32_16x16x32_bf16 v[108:111], v[148:151], a[80:83], v[108:111]
    buffer_load_dwordx4 v[144:147], v4, s[24:27], s40 offen offset:1024
    v_mfma_f32_16x16x32_bf16 v[112:115], v[148:151], a[84:87], v[112:115]
    v_mfma_f32_16x16x32_bf16 v[116:119], v[148:151], a[88:91], v[116:119]
    ds_write_b128 v43, v[100:103] offset:18432
    v_mfma_f32_16x16x32_bf16 v[120:123], v[148:151], a[92:95], v[120:123]
    v_mfma_f32_16x16x32_bf16 v[108:111], v[152:155], a[112:115], v[108:111]
    buffer_load_dwordx4 v[148:151], v4, s[24:27], s40 offen offset:2048
    v_mfma_f32_16x16x32_bf16 v[112:115], v[152:155], a[116:119], v[112:115]
    v_mfma_f32_16x16x32_bf16 v[116:119], v[152:155], a[120:123], v[116:119]
    ds_write_b128 v43, v[104:107] offset:19456
    v_mfma_f32_16x16x32_bf16 v[120:123], v[152:155], a[124:127], v[120:123]
    v_mfma_f32_16x16x32_bf16 v[108:111], v[156:159], a[144:147], v[108:111]
    buffer_load_dwordx4 v[152:155], v4, s[24:27], s40 offen offset:3072
    v_mfma_f32_16x16x32_bf16 v[112:115], v[156:159], a[148:151], v[112:115]
    v_mfma_f32_16x16x32_bf16 v[116:119], v[156:159], a[152:155], v[116:119]
    buffer_load_dwordx4 v5, s[28:31], 0 offen offset:2048 lds
    v_mfma_f32_16x16x32_bf16 v[120:123], v[156:159], a[156:159], v[120:123]
    v_mfma_f32_16x16x32_bf16 v[108:111], v[160:163], a[176:179], v[108:111]
    s_waitcnt lgkmcnt(0)
    s_barrier
    v_mfma_f32_16x16x32_bf16 v[112:115], v[160:163], a[180:183], v[112:115]
    buffer_load_dwordx4 v[156:159], v5, s[24:27], s40 offen offset:0
    v_mfma_f32_16x16x32_bf16 v[116:119], v[160:163], a[184:187], v[116:119]
    v_mfma_f32_16x16x32_bf16 v[120:123], v[160:163], a[188:191], v[120:123]
    v_mfma_f32_16x16x32_bf16 v[108:111], v[164:167], a[208:211], v[108:111]
    v_mfma_f32_16x16x32_bf16 v[112:115], v[164:167], a[212:215], v[112:115]
    buffer_load_dwordx4 v[160:163], v5, s[24:27], s40 offen offset:1024
    v_mfma_f32_16x16x32_bf16 v[116:119], v[164:167], a[216:219], v[116:119]
    v_mfma_f32_16x16x32_bf16 v[120:123], v[164:167], a[220:223], v[120:123]
    v_mfma_f32_16x16x32_bf16 v[92:95], v[196:199], a[0:3], 0
    buffer_load_dwordx4 v[164:167], v5, s[24:27], s40 offen offset:2048
    s_waitcnt vmcnt(29)
    v_mfma_f32_16x16x32_bf16 v[96:99], v[196:199], a[4:7], 0
    v_mfma_f32_16x16x32_bf16 v[100:103], v[196:199], a[8:11], 0
    v_mfma_f32_16x16x32_bf16 v[104:107], v[196:199], a[12:15], 0
    v_fmac_f32 v108, v32, v48
    v_fmac_f32 v109, v32, v49
    v_mfma_f32_16x16x32_bf16 v[92:95], v[200:203], a[32:35], v[92:95]
    s_add_u32 m0, s4, 3072
    s_nop 0
    buffer_load_dwordx4 v5, s[28:31], s50 offen offset:0 lds
    v_mul_f32 v76, v33, v108
    v_mfma_f32_16x16x32_bf16 v[96:99], v[200:203], a[36:39], v[96:99]
    v_mul_f32 v77, v33, v109
    v_fmac_f32 v110, v32, v50
    v_mfma_f32_16x16x32_bf16 v[100:103], v[200:203], a[40:43], v[100:103]
    v_exp_f32 v76, v76
    v_mfma_f32_16x16x32_bf16 v[104:107], v[200:203], a[44:47], v[104:107]
    buffer_load_dwordx4 v5, s[28:31], s50 offen offset:1024 lds
    v_fmac_f32 v111, v32, v51
    v_mfma_f32_16x16x32_bf16 v[92:95], v[204:207], a[64:67], v[92:95]
    v_exp_f32 v77, v77
    v_fma_f32 v76, v76, v34, v34
    v_mfma_f32_16x16x32_bf16 v[96:99], v[204:207], a[68:71], v[96:99]
    v_fma_f32 v77, v77, v34, v34
    v_mul_f32 v108, v108, v110
    v_mfma_f32_16x16x32_bf16 v[100:103], v[204:207], a[72:75], v[100:103]
    v_rcp_f32 v76, v76
    v_mfma_f32_16x16x32_bf16 v[104:107], v[204:207], a[76:79], v[104:107]
    buffer_load_dwordx4 v5, s[28:31], s50 offen offset:2048 lds
    v_mul_f32 v109, v109, v111
    v_mfma_f32_16x16x32_bf16 v[92:95], v[208:211], a[96:99], v[92:95]
    v_rcp_f32 v77, v77
    v_mul_f32 v108, v108, v76
    v_mfma_f32_16x16x32_bf16 v[96:99], v[208:211], a[100:103], v[96:99]
    v_mul_f32 v109, v109, v77
    v_fmac_f32 v116, v40, v48
    v_mfma_f32_16x16x32_bf16 v[100:103], v[208:211], a[104:107], v[100:103]
    s_add_u32 m0, s4, 6144
    s_nop 0
    buffer_load_dwordx4 v5, s[28:31], s51 offen offset:0 lds
    v_mfma_f32_16x16x32_bf16 v[104:107], v[208:211], a[108:111], v[104:107]
    v_cvt_pk_bf16_f32 v84, v108, v109
    v_mfma_f32_16x16x32_bf16 v[92:95], v[212:215], a[128:131], v[92:95]
    ds_read_b128 v[124:127], v47 offset:16384
    v_fmac_f32 v117, v40, v49
    v_mul_f32 v80, v41, v116
    v_mfma_f32_16x16x32_bf16 v[96:99], v[212:215], a[132:135], v[96:99]
    ds_read_b128 v[128:131], v47 offset:17408
    v_mul_f32 v81, v41, v117
    v_mfma_f32_16x16x32_bf16 v[100:103], v[212:215], a[136:139], v[100:103]
    ds_read_b128 v[132:135], v47 offset:18432
    buffer_load_dwordx4 v5, s[28:31], s51 offen offset:1024 lds
    v_mfma_f32_16x16x32_bf16 v[104:107], v[212:215], a[140:143], v[104:107]
    ds_read_b128 v[136:139], v47 offset:19456
    v_fmac_f32 v118, v40, v50
    v_mfma_f32_16x16x32_bf16 v[92:95], v[216:219], a[160:163], v[92:95]
    v_exp_f32 v80, v80
    v_fmac_f32 v119, v40, v51
    v_mfma_f32_16x16x32_bf16 v[96:99], v[216:219], a[164:167], v[96:99]
    buffer_load_dwordx4 v5, s[28:31], s51 offen offset:2048 lds
    v_fma_f32 v80, v80, v42, v42
    v_mfma_f32_16x16x32_bf16 v[100:103], v[216:219], a[168:171], v[100:103]
    v_exp_f32 v81, v81
    v_mfma_f32_16x16x32_bf16 v[104:107], v[216:219], a[172:175], v[104:107]
    v_fma_f32 v81, v81, v42, v42
    v_mul_f32 v116, v116, v118
    v_mfma_f32_16x16x32_bf16 v[92:95], v[220:223], a[192:195], v[92:95]
    v_rcp_f32 v80, v80
    v_mul_f32 v117, v117, v119
    v_mfma_f32_16x16x32_bf16 v[96:99], v[220:223], a[196:199], v[96:99]
    s_add_u32 m0, s4, 9216
    s_nop 0
    buffer_load_dwordx4 v5, s[28:31], s52 offen offset:0 lds
    v_mfma_f32_16x16x32_bf16 v[100:103], v[220:223], a[200:203], v[100:103]
L_tf5:
    s_cbranch_execz L_tret
    v_rcp_f32 v81, v81
    v_mfma_f32_16x16x32_bf16 v[104:107], v[220:223], a[204:207], v[104:107]
    v_mul_f32 v116, v116, v80
    s_waitcnt lgkmcnt(0)
    v_mfma_f32_16x16x32_bf16 v[124:127], v[168:171], a[16:19], v[124:127]
    buffer_load_dwordx4 v5, s[28:31], s52 offen offset:1024 lds
    v_mul_f32 v117, v117, v81
    v_fmac_f32 v112, v36, v48
    v_mfma_f32_16x16x32_bf16 v[128:131], v[168:171], a[20:23], v[128:131]
    v_cvt_pk_bf16_f32 v86, v116, v117
    v_fmac_f32 v113, v36, v49
    v_mfma_f32_16x16x32_bf16 v[132:135], v[168:171], a[24:27], v[132:135]
    ds_write_b128 v43, v[92:95] offset:0
    v_mfma_f32_16x16x32_bf16 v[136:139], v[168:171], a[28:31], v[136:139]
    v_permlane32_swap_b32 v84, v86
    v_mul_f32 v78, v37, v112
    v_mfma_f32_16x16x32_bf16 v[124:127], v[172:175], a[48:51], v[124:127]
    buffer_load_dwordx4 v[168:171], v4, s[24:27], s42 offen offset:0
    v_mul_f32 v79, v37, v113
    v_fmac_f32 v114, v36, v50
    v_mfma_f32_16x16x32_bf16 v[128:131], v[172:175], a[52:55], v[128:131]
    v_exp_f32 v78, v78
    v_mfma_f32_16x16x32_bf16 v[132:135], v[172:175], a[56:59], v[132:135]
    ds_write_b128 v43, v[96:99] offset:1024
    v_mfma_f32_16x16x32_bf16 v[136:139], v[172:175], a[60:63], v[136:139]
    buffer_load_dwordx4 v[172:175], v4, s[24:27], s42 offen offset:1024
    v_fmac_f32 v115, v36, v51
    v_mfma_f32_16x16x32_bf16 v[124:127], v[176:179], a[80:83], v[124:127]
    v_exp_f32 v79, v79
    v_fma_f32 v78, v78, v38, v38
    v_mfma_f32_16x16x32_bf16 v[128:131], v[176:179], a[84:87], v[128:131]
    v_fma_f32 v79, v79, v38, v38
    v_mul_f32 v112, v112, v114
    v_mfma_f32_16x16x32_bf16 v[132:135], v[176:179], a[88:91], v[132:135]
    ds_write_b128 v43, v[100:103] offset:2048
    v_mfma_f32_16x16x32_bf16 v[136:139], v[176:179], a[92:95], v[136:139]
    buffer_load_dwordx4 v[176:179], v4, s[24:27], s42 offen offset:2048
    v_mul_f32 v113, v113, v115
    v_mfma_f32_16x16x32_bf16 v[124:127], v[180:183], a[112:115], v[124:127]
    v_rcp_f32 v78, v78
    v_fmac_f32 v120, v44, v48
    v_mfma_f32_16x16x32_bf16 v[128:131], v[180:183], a[116:119], v[128:131]
    v_rcp_f32 v79, v79
    v_mfma_f32_16x16x32_bf16 v[132:135], v[180:183], a[120:123], v[132:135]
    ds_write_b128 v43, v[104:107] offset:3072
    v_mfma_f32_16x16x32_bf16 v[136:139], v[180:183], a[124:127], v[136:139]
    buffer_load_dwordx4 v[180:183], v4, s[24:27], s42 offen offset:3072
    v_mul_f32 v112, v112, v78
    v_mfma_f32_16x16x32_bf16 v[124:127], v[184:187], a[144:147], v[124:127]
    v_mul_f32 v113, v113, v79
    v_fmac_f32 v121, v44, v49
    v_mul_f32 v82, v45, v120
    v_mfma_f32_16x16x32_bf16 v[128:131], v[184:187], a[148:151], v[128:131]
    v_cvt_pk_bf16_f32 v85, v112, v113
    v_mul_f32 v83, v45, v121
    v_mfma_f32_16x16x32_bf16 v[132:135], v[184:187], a[152:155], v[132:135]
    buffer_load_dwordx4 v5, s[28:31], s52 offen offset:2048 lds
    v_fmac_f32 v122, v44, v50
    v_mfma_f32_16x16x32_bf16 v[136:139], v[184:187], a[156:159], v[136:139]
    v_exp_f32 v82, v82
    v_mfma_f32_16x16x32_bf16 v[124:127], v[188:191], a[176:179], v[124:127]
    s_waitcnt lgkmcnt(0)
    s_barrier
    v_fmac_f32 v123, v44, v51
    v_mfma_f32_16x16x32_bf16 v[128:131], v[188:191], a[180:183], v[128:131]
    buffer_load_dwordx4 v[184:187], v5, s[24:27], s42 offen offset:0
    v_fma_f32 v82, v82, v46, v46
    v_mfma_f32_16x16x32_bf16 v[132:135], v[188:191], a[184:187], v[132:135]
    v_exp_f32 v83, v83
    v_mfma_f32_16x16x32_bf16 v[136:139], v[188:191], a[188:191], v[136:139]
    v_fma_f32 v83, v83, v46, v46
    v_mul_f32 v120, v120, v122
    v_mfma_f32_16x16x32_bf16 v[124:127], v[192:195], a[208:211], v[124:127]
    v_rcp_f32 v82, v82
    v_mul_f32 v121, v121, v123
    v_mfma_f32_16x16x32_bf16 v[128:131], v[192:195], a[212:215], v[128:131]
    buffer_load_dwordx4 v[188:191], v5, s[24:27], s42 offen offset:1024
    v_mul_f32 v120, v120, v82
    v_mfma_f32_16x16x32_bf16 v[132:135], v[192:195], a[216:219], v[132:135]
    v_rcp_f32 v83, v83
    v_mfma_f32_16x16x32_bf16 v[136:139], v[192:195], a[220:223], v[136:139]
    v_mul_f32 v121, v121, v83
    s_waitcnt vmcnt(40)
    v_mfma_f32_16x16x32_bf16 v[92:95], v[224:227], a[0:3], 0
    buffer_load_dwordx4 v[192:195], v5, s[24:27], s42 offen offset:2048
    v_cvt_pk_bf16_f32 v87, v120, v121
    v_mfma_f32_16x16x32_bf16 v[96:99], v[224:227], a[4:7], 0
    s_nop 0
    v_permlane32_swap_b32 v85, v87
    v_mfma_f32_16x16x32_bf16 v[100:103], v[224:227], a[8:11], 0
    s_nop 0
    v_permlane16_swap_b32 v84, v85
    v_permlane16_swap_b32 v86, v87
    v_mfma_f32_16x16x32_bf16 v[104:107], v[224:227], a[12:15], 0
    buffer_store_dwordx4 v[84:87], v12, s[20:23], 0 offen sc1
    v_fmac_f32 v124, v32, v52
    v_mfma_f32_16x16x32_bf16 v[92:95], v[228:231], a[32:35], v[92:95]
    v_fmac_f32 v125, v32, v53
    v_mul_f32 v76, v33, v124
    v_fmac_f32 v126, v32, v54
    v_mfma_f32_16x16x32_bf16 v[96:99], v[228:231], a[36:39], v[96:99]
    v_mul_f32 v77, v33, v125
    v_fmac_f32 v127, v32, v55
    v_mfma_f32_16x16x32_bf16 v[100:103], v[228:231], a[40:43], v[100:103]
    v_exp_f32 v76, v76
    v_mfma_f32_16x16x32_bf16 v[104:107], v[228:231], a[44:47], v[104:107]
    v_exp_f32 v77, v77
    v_mfma_f32_16x16x32_bf16 v[92:95], v[232:235], a[64:67], v[92:95]
    v_fma_f32 v76, v76, v34, v34
    v_fma_f32 v77, v77, v34, v34
    v_mul_f32 v124, v124, v126
    v_mfma_f32_16x16x32_bf16 v[96:99], v[232:235], a[68:71], v[96:99]
    v_rcp_f32 v76, v76
    v_mfma_f32_16x16x32_bf16 v[100:103], v[232:235], a[72:75], v[100:103]
    v_rcp_f32 v77, v77
    v_mfma_f32_16x16x32_bf16 v[104:107], v[232:235], a[76:79], v[104:107]
    s_add_u32 m0, s4, 12288
    s_nop 0
    buffer_load_dwordx4 v5, s[28:31], s53 offen offset:0 lds
    v_mfma_f32_16x16x32_bf16 v[92:95], v[236:239], a[96:99], v[92:95]
    v_mul_f32 v125, v125, v127
    v_mul_f32 v124, v124, v76
    v_fmac_f32 v132, v40, v52
    v_mfma_f32_16x16x32_bf16 v[96:99], v[236:239], a[100:103], v[96:99]
    v_mul_f32 v125, v125, v77
    v_fmac_f32 v133, v40, v53
    v_mfma_f32_16x16x32_bf16 v[100:103], v[236:239], a[104:107], v[100:103]
    buffer_load_dwordx4 v5, s[28:31], s53 offen offset:1024 lds
    v_cvt_pk_bf16_f32 v88, v124, v125
    v_mfma_f32_16x16x32_bf16 v[104:107], v[236:239], a[108:111], v[104:107]
    v_mul_f32 v80, v41, v132
    s_waitcnt vmcnt(40)
    v_mfma_f32_16x16x32_bf16 v[92:95], v[240:243], a[128:131], v[92:95]
    ds_read_b128 v[108:111], v47 offset:0
    v_mul_f32 v81, v41, v133
    v_fmac_f32 v134, v40, v54
    v_mfma_f32_16x16x32_bf16 v[96:99], v[240:243], a[132:135], v[96:99]
    ds_read_b128 v[112:115], v47 offset:1024
    v_fmac_f32 v135, v40, v55
    v_mfma_f32_16x16x32_bf16 v[100:103], v[240:243], a[136:139], v[100:103]
    ds_read_b128 v[116:119], v47 offset:2048
    buffer_load_dwordx4 v5, s[28:31], s53 offen offset:2048 lds
    v_mfma_f32_16x16x32_bf16 v[104:107], v[240:243], a[140:143], v[104:107]
    ds_read_b128 v[120:123], v47 offset:3072
    v_mul_f32 v132, v132, v134
    v_mfma_f32_16x16x32_bf16 v[92:95], v[244:247], a[160:163], v[92:95]
    v_exp_f32 v80, v80
    v_mul_f32 v133, v133, v135
    v_mfma_f32_16x16x32_bf16 v[96:99], v[244:247], a[164:167], v[96:99]
    s_add_u32 m0, s4, 15360
    s_nop 0
    buffer_load_dwordx4 v5, s[28:31], s54 offen offset:0 lds
    v_mfma_f32_16x16x32_bf16 v[100:103], v[244:247], a[168:171], v[100:103]
    v_exp_f32 v81, v81
    v_mfma_f32_16x16x32_bf16 v[104:107], v[244:247], a[172:175], v[104:107]
    v_fma_f32 v80, v80, v42, v42
    v_fma_f32 v81, v81, v42, v42
    v_mfma_f32_16x16x32_bf16 v[92:95], v[248:251], a[192:195], v[92:95]
    v_rcp_f32 v80, v80
    v_fmac_f32 v128, v36, v52
    v_mfma_f32_16x16x32_bf16 v[96:99], v[248:251], a[196:199], v[96:99]
    buffer_load_dwordx4 v5, s[28:31], s54 offen offset:1024 lds
    v_mul_f32 v132, v132, v80
    v_mfma_f32_16x16x32_bf16 v[100:103], v[248:251], a[200:203], v[100:103]
    v_rcp_f32 v81, v81
    v_mfma_f32_16x16x32_bf16 v[104:107], v[248:251], a[204:207], v[104:107]
    v_mul_f32 v133, v133, v81
    s_waitcnt lgkmcnt(0)
    v_mfma_f32_16x16x32_bf16 v[108:111], v[196:199], a[16:19], v[108:111]
    buffer_load_dwordx4 v5, s[28:31], s54 offen offset:2048 lds
    v_cvt_pk_bf16_f32 v90, v132, v133
    v_fmac_f32 v129, v36, v53
    v_mfma_f32_16x16x32_bf16 v[112:115], v[196:199], a[20:23], v[112:115]
    v_permlane32_swap_b32 v88, v90
    v_mul_f32 v78, v37, v128
    v_mfma_f32_16x16x32_bf16 v[116:119], v[196:199], a[24:27], v[116:119]
L_tf6:
    s_cbranch_execz L_tret
    ds_write_b128 v43, v[92:95] offset:16384
    v_mfma_f32_16x16x32_bf16 v[120:123], v[196:199], a[28:31], v[120:123]
    v_mul_f32 v79, v37, v129
    v_fmac_f32 v130, v36, v54
    v_mfma_f32_16x16x32_bf16 v[108:111], v[200:203], a[48:51], v[108:111]
    buffer_load_dwordx4 v[196:199], v4, s[24:27], s43 offen offset:0
    v_exp_f32 v78, v78
    v_mfma_f32_16x16x32_bf16 v[112:115], v[200:203], a[52:55], v[112:115]
    v_exp_f32 v79, v79
    v_mfma_f32_16x16x32_bf16 v[116:119], v[200:203], a[56:59], v[116:119]
    ds_write_b128 v43, v[96:99] offset:17408
    v_mfma_f32_16x16x32_bf16 v[120:123], v[200:203], a[60:63], v[120:123]
    buffer_load_dwordx4 v[200:203], v4, s[24:27], s43 offen offset:1024
    v_fmac_f32 v131, v36, v55
    v_mfma_f32_16x16x32_bf16 v[108:111], v[204:207], a[80:83], v[108:111]
    v_fma_f32 v78, v78, v38, v38
    v_fma_f32 v79, v79, v38, v38
    v_mul_f32 v128, v128, v130
    v_mfma_f32_16x16x32_bf16 v[112:115], v[204:207], a[84:87], v[112:115]
    v_rcp_f32 v78, v78
    v_mfma_f32_16x16x32_bf16 v[116:119], v[204:207], a[88:91], v[116:119]
    ds_write_b128 v43, v[100:103] offset:18432
    v_mfma_f32_16x16x32_bf16 v[120:123], v[204:207], a[92:95], v[120:123]
    buffer_load_dwordx4 v[204:207], v4, s[24:27], s43 offen offset:2048
    v_mul_f32 v129, v129, v131
    v_mfma_f32_16x16x32_bf16 v[108:111], v[208:211], a[112:115], v[108:111]
    v_rcp_f32 v79, v79
    v_mul_f32 v128, v128, v78
    v_mfma_f32_16x16x32_bf16 v[112:115], v[208:211], a[116:119], v[112:115]
    v_mul_f32 v129, v129, v79
    v_fmac_f32 v136, v44, v52
    v_mfma_f32_16x16x32_bf16 v[116:119], v[208:211], a[120:123], v[116:119]
    ds_write_b128 v43, v[104:107] offset:19456
    v_mfma_f32_16x16x32_bf16 v[120:123], v[208:211], a[124:127], v[120:123]
    buffer_load_dwordx4 v[208:211], v4, s[24:27], s43 offen offset:3072
    v_cvt_pk_bf16_f32 v89, v128, v129
    v_mfma_f32_16x16x32_bf16 v[108:111], v[212:215], a[144:147], v[108:111]
    v_fmac_f32 v137, v44, v53
    v_mul_f32 v82, v45, v136
    v_fmac_f32 v138, v44, v54
    v_mfma_f32_16x16x32_bf16 v[112:115], v[212:215], a[148:151], v[112:115]
    v_mul_f32 v83, v45, v137
    v_fmac_f32 v139, v44, v55
    v_mfma_f32_16x16x32_bf16 v[116:119], v[212:215], a[152:155], v[116:119]
    s_add_u32 m0, s4, 18432
    s_nop 0
    buffer_load_dwordx4 v5, s[28:31], s55 offen offset:0 lds
    v_mfma_f32_16x16x32_bf16 v[120:123], v[212:215], a[156:159], v[120:123]
    v_exp_f32 v82, v82
    v_mfma_f32_16x16x32_bf16 v[108:111], v[216:219], a[176:179], v[108:111]
    s_waitcnt lgkmcnt(0)
    s_barrier
    v_fma_f32 v82, v82, v46, v46
    v_mfma_f32_16x16x32_bf16 v[112:115], v[216:219], a[180:183], v[112:115]
    buffer_load_dwordx4 v[212:215], v5, s[24:27], s43 offen offset:0
    v_mul_f32 v136, v136, v138
    v_mfma_f32_16x16x32_bf16 v[116:119], v[216:219], a[184:187], v[116:119]
    v_exp_f32 v83, v83
    v_mfma_f32_16x16x32_bf16 v[120:123], v[216:219], a[188:191], v[120:123]
    v_fma_f32 v83, v83, v46, v46
    v_mul_f32 v137, v137, v139
    v_mfma_f32_16x16x32_bf16 v[108:111], v[220:223], a[208:211], v[108:111]
    v_rcp_f32 v82, v82
    v_mfma_f32_16x16x32_bf16 v[112:115], v[220:223], a[212:215], v[112:115]
    s_waitcnt vmcnt(12)
    buffer_store_dword v31, v28, s[32:35], 0 offen offset:0 sc1
    v_mul_f32 v136, v136, v82
    v_mfma_f32_16x16x32_bf16 v[116:119], v[220:223], a[216:219], v[116:119]
    buffer_load_dwordx4 v[216:219], v5, s[24:27], s43 offen offset:1024
    v_mfma_f32_16x16x32_bf16 v[120:123], v[220:223], a[220:223], v[120:123]
    v_mfma_f32_16x16x32_bf16 v[92:95], v[140:143], a[0:3], 0
    buffer_load_dwordx4 v[220:223], v5, s[24:27], s43 offen offset:2048
    v_rcp_f32 v83, v83
    v_mfma_f32_16x16x32_bf16 v[96:99], v[140:143], a[4:7], 0
    v_mul_f32 v137, v137, v83
    v_mfma_f32_16x16x32_bf16 v[100:103], v[140:143], a[8:11], 0
    v_cvt_pk_bf16_f32 v91, v136, v137
    v_mfma_f32_16x16x32_bf16 v[104:107], v[140:143], a[12:15], 0
    s_nop 0
    v_permlane32_swap_b32 v89, v91
    v_fmac_f32 v108, v32, v56
    v_mfma_f32_16x16x32_bf16 v[92:95], v[144:147], a[32:35], v[92:95]
    buffer_load_dwordx4 v5, s[28:31], s55 offen offset:1024 lds
    v_permlane16_swap_b32 v88, v89
    v_permlane16_swap_b32 v90, v91
    v_mfma_f32_16x16x32_bf16 v[96:99], v[144:147], a[36:39], v[96:99]
    buffer_store_dwordx4 v[88:91], v13, s[20:23], 0 offen sc1
    v_fmac_f32 v109, v32, v57
    v_mfma_f32_16x16x32_bf16 v[100:103], v[144:147], a[40:43], v[100:103]
    v_mul_f32 v76, v33, v108
    v_mul_f32 v77, v33, v109
    v_mfma_f32_16x16x32_bf16 v[104:107], v[144:147], a[44:47], v[104:107]
    v_exp_f32 v76, v76
    v_mfma_f32_16x16x32_bf16 v[92:95], v[148:151], a[64:67], v[92:95]
    v_exp_f32 v77, v77
    v_fmac_f32 v110, v32, v58
    v_mfma_f32_16x16x32_bf16 v[96:99], v[148:151], a[68:71], v[96:99]
    v_fmac_f32 v111, v32, v59
    v_fma_f32 v76, v76, v34, v34
    v_mfma_f32_16x16x32_bf16 v[100:103], v[148:151], a[72:75], v[100:103]
    v_fma_f32 v77, v77, v34, v34
    v_mul_f32 v108, v108, v110
    v_mfma_f32_16x16x32_bf16 v[104:107], v[148:151], a[76:79], v[104:107]
    v_rcp_f32 v76, v76
    v_mfma_f32_16x16x32_bf16 v[92:95], v[152:155], a[96:99], v[92:95]
    v_rcp_f32 v77, v77
    v_mul_f32 v109, v109, v111
    v_mfma_f32_16x16x32_bf16 v[96:99], v[152:155], a[100:103], v[96:99]
    v_mul_f32 v108, v108, v76
    v_mul_f32 v109, v109, v77
    v_mfma_f32_16x16x32_bf16 v[100:103], v[152:155], a[104:107], v[100:103]
    buffer_load_dwordx4 v5, s[28:31], s55 offen offset:2048 lds
    v_cvt_pk_bf16_f32 v84, v108, v109
    v_mfma_f32_16x16x32_bf16 v[104:107], v[152:155], a[108:111], v[104:107]
    v_fmac_f32 v116, v40, v56
    v_mfma_f32_16x16x32_bf16 v[92:95], v[156:159], a[128:131], v[92:95]
    ds_read_b128 v[124:127], v47 offset:16384
    v_fmac_f32 v117, v40, v57
    v_mul_f32 v80, v41, v116
    v_mfma_f32_16x16x32_bf16 v[96:99], v[156:159], a[132:135], v[96:99]
    ds_read_b128 v[128:131], v47 offset:17408
    v_mul_f32 v81, v41, v117
    v_mfma_f32_16x16x32_bf16 v[100:103], v[156:159], a[136:139], v[100:103]
    ds_read_b128 v[132:135], v47 offset:18432
    s_add_u32 m0, s4, 21504
    s_nop 0
    buffer_load_dwordx4 v5, s[28:31], s56 offen offset:0 lds
    v_mfma_f32_16x16x32_bf16 v[104:107], v[156:159], a[140:143], v[104:107]
    ds_read_b128 v[136:139], v47 offset:19456
    v_fmac_f32 v118, v40, v58
    v_mfma_f32_16x16x32_bf16 v[92:95], v[160:163], a[160:163], v[92:95]
    v_exp_f32 v80, v80
    v_fmac_f32 v119, v40, v59
    v_mfma_f32_16x16x32_bf16 v[96:99], v[160:163], a[164:167], v[96:99]
    buffer_load_dwordx4 v5, s[28:31], s56 offen offset:1024 lds
    v_fma_f32 v80, v80, v42, v42
    v_mfma_f32_16x16x32_bf16 v[100:103], v[160:163], a[168:171], v[100:103]
    v_exp_f32 v81, v81
    v_mfma_f32_16x16x32_bf16 v[104:107], v[160:163], a[172:175], v[104:107]
    v_fma_f32 v81, v81, v42, v42
    v_mul_f32 v116, v116, v118
    v_mfma_f32_16x16x32_bf16 v[92:95], v[164:167], a[192:195], v[92:95]
    v_rcp_f32 v80, v80
    v_mul_f32 v117, v117, v119
    v_mfma_f32_16x16x32_bf16 v[96:99], v[164:167], a[196:199], v[96:99]
    buffer_load_dwordx4 v5, s[28:31], s56 offen offset:2048 lds
    v_mul_f32 v116, v116, v80
    v_mfma_f32_16x16x32_bf16 v[100:103], v[164:167], a[200:203], v[100:103]
    v_rcp_f32 v81, v81
    v_mfma_f32_16x16x32_bf16 v[104:107], v[164:167], a[204:207], v[104:107]
    v_mul_f32 v117, v117, v81
    s_waitcnt lgkmcnt(0)
    v_mfma_f32_16x16x32_bf16 v[124:127], v[224:227], a[16:19], v[124:127]
    buffer_load_dwordx4 a[224:227], v4, s[28:31], s56 offen offset:0
    v_cvt_pk_bf16_f32 v86, v116, v117
    v_fmac_f32 v112, v36, v56
    v_mfma_f32_16x16x32_bf16 v[128:131], v[224:227], a[20:23], v[128:131]
    v_permlane32_swap_b32 v84, v86
    v_fmac_f32 v113, v36, v57
    v_mfma_f32_16x16x32_bf16 v[132:135], v[224:227], a[24:27], v[132:135]
    ds_write_b128 v43, v[92:95] offset:0
L_tf7:
    s_cbranch_execz L_tret
    v_mfma_f32_16x16x32_bf16 v[136:139], v[224:227], a[28:31], v[136:139]
    v_mul_f32 v78, v37, v112
    v_mul_f32 v79, v37, v113
    v_mfma_f32_16x16x32_bf16 v[124:127], v[228:231], a[48:51], v[124:127]
    buffer_load_dwordx4 v[252:255], v4, s[28:31], 0 offen offset:1024
    v_exp_f32 v78, v78
    v_mfma_f32_16x16x32_bf16 v[128:131], v[228:231], a[52:55], v[128:131]
    v_exp_f32 v79, v79
    v_mfma_f32_16x16x32_bf16 v[132:135], v[228:231], a[56:59], v[132:135]
    ds_write_b128 v43, v[96:99] offset:1024
    v_mfma_f32_16x16x32_bf16 v[136:139], v[228:231], a[60:63], v[136:139]
    buffer_load_dwordx4 v[224:227], v4, s[28:31], s50 offen offset:1024
    v_fmac_f32 v114, v36, v58
    v_mfma_f32_16x16x32_bf16 v[124:127], v[232:235], a[80:83], v[124:127]
    v_fmac_f32 v115, v36, v59
    v_fma_f32 v78, v78, v38, v38
    v_fma_f32 v79, v79, v38, v38
    v_mfma_f32_16x16x32_bf16 v[128:131], v[232:235], a[84:87], v[128:131]
    v_rcp_f32 v78, v78
    v_mfma_f32_16x16x32_bf16 v[132:135], v[232:235], a[88:91], v[132:135]
    ds_write_b128 v43, v[100:103] offset:2048
    v_mfma_f32_16x16x32_bf16 v[136:139], v[232:235], a[92:95], v[136:139]
    buffer_load_dwordx4 v[228:231], v4, s[28:31], s51 offen offset:1024
    v_mul_f32 v112, v112, v114
    v_mfma_f32_16x16x32_bf16 v[124:127], v[236:239], a[112:115], v[124:127]
    v_rcp_f32 v79, v79
    v_mul_f32 v113, v113, v115
    v_mfma_f32_16x16x32_bf16 v[128:131], v[236:239], a[116:119], v[128:131]
    v_mul_f32 v112, v112, v78
    v_mul_f32 v113, v113, v79
    v_mfma_f32_16x16x32_bf16 v[132:135], v[236:239], a[120:123], v[132:135]
    ds_write_b128 v43, v[104:107] offset:3072
    v_mfma_f32_16x16x32_bf16 v[136:139], v[236:239], a[124:127], v[136:139]
    buffer_load_dwordx4 v[232:235], v4, s[28:31], s52 offen offset:1024
    v_cvt_pk_bf16_f32 v85, v112, v113
    v_mfma_f32_16x16x32_bf16 v[124:127], v[240:243], a[144:147], v[124:127]
    v_fmac_f32 v120, v44, v56
    v_fmac_f32 v121, v44, v57
    v_fmac_f32 v122, v44, v58
    v_mfma_f32_16x16x32_bf16 v[128:131], v[240:243], a[148:151], v[128:131]
    v_mul_f32 v82, v45, v120
    v_mul_f32 v83, v45, v121
    v_mfma_f32_16x16x32_bf16 v[132:135], v[240:243], a[152:155], v[132:135]
    buffer_load_dwordx4 v[236:239], v4, s[28:31], s53 offen offset:1024
    v_fmac_f32 v123, v44, v59
    v_mfma_f32_16x16x32_bf16 v[136:139], v[240:243], a[156:159], v[136:139]
    v_exp_f32 v82, v82
    v_mfma_f32_16x16x32_bf16 v[124:127], v[244:247], a[176:179], v[124:127]
    s_waitcnt lgkmcnt(0)
    s_barrier
    v_fma_f32 v82, v82, v46, v46
    v_mfma_f32_16x16x32_bf16 v[128:131], v[244:247], a[180:183], v[128:131]
    buffer_load_dwordx4 v[240:243], v4, s[28:31], s54 offen offset:1024
    v_mul_f32 v120, v120, v122
    v_mfma_f32_16x16x32_bf16 v[132:135], v[244:247], a[184:187], v[132:135]
    v_exp_f32 v83, v83
    v_mfma_f32_16x16x32_bf16 v[136:139], v[244:247], a[188:191], v[136:139]
    v_fma_f32 v83, v83, v46, v46
    v_mul_f32 v121, v121, v123
    v_mfma_f32_16x16x32_bf16 v[124:127], v[248:251], a[208:211], v[124:127]
    v_rcp_f32 v82, v82
    v_mfma_f32_16x16x32_bf16 v[128:131], v[248:251], a[212:215], v[128:131]
    buffer_load_dwordx4 v[244:247], v4, s[28:31], s55 offen offset:1024
    v_mul_f32 v120, v120, v82
    v_mfma_f32_16x16x32_bf16 v[132:135], v[248:251], a[216:219], v[132:135]
    v_rcp_f32 v83, v83
    v_mfma_f32_16x16x32_bf16 v[136:139], v[248:251], a[220:223], v[136:139]
    v_mul_f32 v121, v121, v83
    v_mfma_f32_16x16x32_bf16 v[92:95], v[168:171], a[0:3], 0
    buffer_load_dword v30, v29, s[32:35], 0 offen offset:0 sc1
    v_cvt_pk_bf16_f32 v87, v120, v121
    v_mfma_f32_16x16x32_bf16 v[96:99], v[168:171], a[4:7], 0
    buffer_load_dwordx4 v[248:251], v4, s[28:31], s56 offen offset:1024
    v_permlane32_swap_b32 v85, v87
    v_mfma_f32_16x16x32_bf16 v[100:103], v[168:171], a[8:11], 0
    s_nop 0
    v_permlane16_swap_b32 v84, v85
    v_permlane16_swap_b32 v86, v87
    v_mfma_f32_16x16x32_bf16 v[104:107], v[168:171], a[12:15], 0
    buffer_store_dwordx4 v[84:87], v14, s[20:23], 0 offen sc1
    v_fmac_f32 v124, v32, v60
    v_mfma_f32_16x16x32_bf16 v[92:95], v[172:175], a[32:35], v[92:95]
    v_fmac_f32 v125, v32, v61
    v_mul_f32 v76, v33, v124
    v_fmac_f32 v126, v32, v62
    v_mfma_f32_16x16x32_bf16 v[96:99], v[172:175], a[36:39], v[96:99]
    v_mul_f32 v77, v33, v125
    v_fmac_f32 v127, v32, v63
    v_mfma_f32_16x16x32_bf16 v[100:103], v[172:175], a[40:43], v[100:103]
    v_exp_f32 v76, v76
    v_mfma_f32_16x16x32_bf16 v[104:107], v[172:175], a[44:47], v[104:107]
    v_exp_f32 v77, v77
    v_mfma_f32_16x16x32_bf16 v[92:95], v[176:179], a[64:67], v[92:95]
    v_fma_f32 v76, v76, v34, v34
    v_fma_f32 v77, v77, v34, v34
    v_mul_f32 v124, v124, v126
    v_mfma_f32_16x16x32_bf16 v[96:99], v[176:179], a[68:71], v[96:99]
    v_rcp_f32 v76, v76
    v_mfma_f32_16x16x32_bf16 v[100:103], v[176:179], a[72:75], v[100:103]
    v_rcp_f32 v77, v77
    v_mfma_f32_16x16x32_bf16 v[104:107], v[176:179], a[76:79], v[104:107]
    v_mul_f32 v125, v125, v127
    v_mul_f32 v124, v124, v76
    v_mfma_f32_16x16x32_bf16 v[92:95], v[180:183], a[96:99], v[92:95]
    v_mul_f32 v125, v125, v77
    v_fmac_f32 v132, v40, v60
    v_fmac_f32 v133, v40, v61
    v_mfma_f32_16x16x32_bf16 v[96:99], v[180:183], a[100:103], v[96:99]
    v_cvt_pk_bf16_f32 v88, v124, v125
    v_mul_f32 v80, v41, v132
    v_mfma_f32_16x16x32_bf16 v[100:103], v[180:183], a[104:107], v[100:103]
    v_mul_f32 v81, v41, v133
    v_fmac_f32 v134, v40, v62
    v_mfma_f32_16x16x32_bf16 v[104:107], v[180:183], a[108:111], v[104:107]
    v_fmac_f32 v135, v40, v63
    v_mfma_f32_16x16x32_bf16 v[92:95], v[184:187], a[128:131], v[92:95]
    ds_read_b128 v[108:111], v47 offset:0
    v_exp_f32 v80, v80
    v_mfma_f32_16x16x32_bf16 v[96:99], v[184:187], a[132:135], v[96:99]
    ds_read_b128 v[112:115], v47 offset:1024
    v_fma_f32 v80, v80, v42, v42
    v_mfma_f32_16x16x32_bf16 v[100:103], v[184:187], a[136:139], v[100:103]
    ds_read_b128 v[116:119], v47 offset:2048
    v_mul_f32 v132, v132, v134
    v_mfma_f32_16x16x32_bf16 v[104:107], v[184:187], a[140:143], v[104:107]
    ds_read_b128 v[120:123], v47 offset:3072
    v_mul_f32 v133, v133, v135
    v_mfma_f32_16x16x32_bf16 v[92:95], v[188:191], a[160:163], v[92:95]
    v_exp_f32 v81, v81
    v_fmac_f32 v128, v36, v60
    v_mfma_f32_16x16x32_bf16 v[96:99], v[188:191], a[164:167], v[96:99]
    v_fma_f32 v81, v81, v42, v42
L_tf8:
    s_cbranch_execz L_tret
    v_fmac_f32 v129, v36, v61
    v_mfma_f32_16x16x32_bf16 v[100:103], v[188:191], a[168:171], v[100:103]
    v_rcp_f32 v80, v80
    v_mfma_f32_16x16x32_bf16 v[104:107], v[188:191], a[172:175], v[104:107]
    v_rcp_f32 v81, v81
    v_mfma_f32_16x16x32_bf16 v[92:95], v[192:195], a[192:195], v[92:95]
    v_mul_f32 v132, v132, v80
    v_mul_f32 v133, v133, v81
    v_mul_f32 v78, v37, v128
    v_mfma_f32_16x16x32_bf16 v[96:99], v[192:195], a[196:199], v[96:99]
    v_cvt_pk_bf16_f32 v90, v132, v133
    v_mul_f32 v79, v37, v129
    v_mfma_f32_16x16x32_bf16 v[100:103], v[192:195], a[200:203], v[100:103]
    v_permlane32_swap_b32 v88, v90
    v_fmac_f32 v130, v36, v62
    v_mfma_f32_16x16x32_bf16 v[104:107], v[192:195], a[204:207], v[104:107]
    v_fmac_f32 v131, v36, v63
    s_waitcnt lgkmcnt(0)
    v_mfma_f32_16x16x32_bf16 v[108:111], v[140:143], a[16:19], v[108:111]
    v_exp_f32 v78, v78
    v_mul_f32 v128, v128, v130
    v_mfma_f32_16x16x32_bf16 v[112:115], v[140:143], a[20:23], v[112:115]
    v_exp_f32 v79, v79
    v_mfma_f32_16x16x32_bf16 v[116:119], v[140:143], a[24:27], v[116:119]
    ds_write_b128 v43, v[92:95] offset:16384
    v_mfma_f32_16x16x32_bf16 v[120:123], v[140:143], a[28:31], v[120:123]
    buffer_load_dwordx4 v[140:143], v4, s[28:31], 0 offen offset:2048
    v_fma_f32 v78, v78, v38, v38
    v_mfma_f32_16x16x32_bf16 v[108:111], v[144:147], a[48:51], v[108:111]
    v_fma_f32 v79, v79, v38, v38
    v_rcp_f32 v78, v78
    v_mfma_f32_16x16x32_bf16 v[112:115], v[144:147], a[52:55], v[112:115]
    v_rcp_f32 v79, v79
    v_mfma_f32_16x16x32_bf16 v[116:119], v[144:147], a[56:59], v[116:119]
    ds_write_b128 v43, v[96:99] offset:17408
    v_mfma_f32_16x16x32_bf16 v[120:123], v[144:147], a[60:63], v[120:123]
    buffer_load_dwordx4 v[144:147], v4, s[28:31], s50 offen offset:2048
    v_mul_f32 v129, v129, v131
    v_mfma_f32_16x16x32_bf16 v[108:111], v[148:151], a[80:83], v[108:111]
    v_mul_f32 v128, v128, v78
    v_mul_f32 v129, v129, v79
    v_fmac_f32 v136, v44, v60
    v_mfma_f32_16x16x32_bf16 v[112:115], v[148:151], a[84:87], v[112:115]
    v_cvt_pk_bf16_f32 v89, v128, v129
    v_fmac_f32 v137, v44, v61
    v_mfma_f32_16x16x32_bf16 v[116:119], v[148:151], a[88:91], v[116:119]
    ds_write_b128 v43, v[100:103] offset:18432
    v_mfma_f32_16x16x32_bf16 v[120:123], v[148:151], a[92:95], v[120:123]
    buffer_load_dwordx4 v[148:151], v4, s[28:31], s51 offen offset:2048
    v_mul_f32 v82, v45, v136
    v_mfma_f32_16x16x32_bf16 v[108:111], v[152:155], a[112:115], v[108:111]
    v_mul_f32 v83, v45, v137
    v_exp_f32 v82, v82
    v_mfma_f32_16x16x32_bf16 v[112:115], v[152:155], a[116:119], v[112:115]
    v_exp_f32 v83, v83
    v_mfma_f32_16x16x32_bf16 v[116:119], v[152:155], a[120:123], v[116:119]
    ds_write_b128 v43, v[104:107] offset:19456
    v_mfma_f32_16x16x32_bf16 v[120:123], v[152:155], a[124:127], v[120:123]
    buffer_load_dwordx4 v[152:155], v4, s[28:31], s52 offen offset:2048
    v_fmac_f32 v138, v44, v62
    v_mfma_f32_16x16x32_bf16 v[108:111], v[156:159], a[144:147], v[108:111]
    v_fmac_f32 v139, v44, v63
    v_fma_f32 v82, v82, v46, v46
    v_fma_f32 v83, v83, v46, v46
    v_mfma_f32_16x16x32_bf16 v[112:115], v[156:159], a[148:151], v[112:115]
    v_rcp_f32 v82, v82
    v_mfma_f32_16x16x32_bf16 v[116:119], v[156:159], a[152:155], v[116:119]
    v_rcp_f32 v83, v83
    v_mfma_f32_16x16x32_bf16 v[120:123], v[156:159], a[156:159], v[120:123]
    buffer_load_dwordx4 v[156:159], v4, s[28:31], s53 offen offset:2048
    v_mul_f32 v136, v136, v138
    v_mfma_f32_16x16x32_bf16 v[108:111], v[160:163], a[176:179], v[108:111]
    s_waitcnt lgkmcnt(0)
    s_barrier
    v_mul_f32 v137, v137, v139
    v_mfma_f32_16x16x32_bf16 v[112:115], v[160:163], a[180:183], v[112:115]
    v_mul_f32 v136, v136, v82
    v_mul_f32 v137, v137, v83
    v_mfma_f32_16x16x32_bf16 v[116:119], v[160:163], a[184:187], v[116:119]
    v_cvt_pk_bf16_f32 v91, v136, v137
    v_mfma_f32_16x16x32_bf16 v[120:123], v[160:163], a[188:191], v[120:123]
    s_waitcnt vmcnt(7)
    v_cmp_ne_u32 vcc, s0, v30
    s_cbranch_vccnz L_ff_slow0
L_ff_back0:
    s_add_u32 s61, s5, 0
    buffer_load_dwordx4 v[160:163], v17, s[36:39], s61 offen sc1
    v_mfma_f32_16x16x32_bf16 v[108:111], v[164:167], a[208:211], v[108:111]
    v_permlane32_swap_b32 v89, v91
    v_mfma_f32_16x16x32_bf16 v[112:115], v[164:167], a[212:215], v[112:115]
    s_nop 0
    v_permlane16_swap_b32 v88, v89
    v_permlane16_swap_b32 v90, v91
    v_mfma_f32_16x16x32_bf16 v[116:119], v[164:167], a[216:219], v[116:119]
    buffer_store_dwordx4 v[88:91], v15, s[20:23], 0 offen sc1
    v_mfma_f32_16x16x32_bf16 v[120:123], v[164:167], a[220:223], v[120:123]
    v_mfma_f32_16x16x32_bf16 v[92:95], v[196:199], a[0:3], 0
    v_mfma_f32_16x16x32_bf16 v[96:99], v[196:199], a[4:7], 0
    v_mfma_f32_16x16x32_bf16 v[100:103], v[196:199], a[8:11], 0
    v_mfma_f32_16x16x32_bf16 v[104:107], v[196:199], a[12:15], 0
    v_fmac_f32 v108, v32, v64
    v_fmac_f32 v109, v32, v65
    v_mfma_f32_16x16x32_bf16 v[92:95], v[200:203], a[32:35], v[92:95]
    buffer_load_dwordx4 a[0:3], v18, s[36:39], s61 offen sc1
    v_mul_f32 v76, v33, v108
    v_mul_f32 v77, v33, v109
    v_mfma_f32_16x16x32_bf16 v[96:99], v[200:203], a[36:39], v[96:99]
    v_exp_f32 v76, v76
    v_mfma_f32_16x16x32_bf16 v[100:103], v[200:203], a[40:43], v[100:103]
    v_exp_f32 v77, v77
    v_mfma_f32_16x16x32_bf16 v[104:107], v[200:203], a[44:47], v[104:107]
    buffer_load_dwordx4 a[4:7], v19, s[36:39], s61 offen sc1
    v_fmac_f32 v110, v32, v66
    v_mfma_f32_16x16x32_bf16 v[92:95], v[204:207], a[64:67], v[92:95]
    v_fmac_f32 v111, v32, v67
    v_fma_f32 v76, v76, v34, v34
    v_fma_f32 v77, v77, v34, v34
    v_mfma_f32_16x16x32_bf16 v[96:99], v[204:207], a[68:71], v[96:99]
    v_rcp_f32 v76, v76
    v_mfma_f32_16x16x32_bf16 v[100:103], v[204:207], a[72:75], v[100:103]
    v_rcp_f32 v77, v77
    v_mfma_f32_16x16x32_bf16 v[104:107], v[204:207], a[76:79], v[104:107]
    buffer_load_dwordx4 a[8:11], v16, s[36:39], s61 offen sc1
    v_mul_f32 v108, v108, v110
    v_mfma_f32_16x16x32_bf16 v[92:95], v[208:211], a[96:99], v[92:95]
    v_mul_f32 v109, v109, v111
    v_mul_f32 v108, v108, v76
    v_fmac_f32 v116, v40, v64
    v_mfma_f32_16x16x32_bf16 v[96:99], v[208:211], a[100:103], v[96:99]
    v_mul_f32 v109, v109, v77
    v_fmac_f32 v117, v40, v65
    v_mfma_f32_16x16x32_bf16 v[100:103], v[208:211], a[104:107], v[100:103]
    s_add_u32 s61, s5, 28672
    buffer_load_dwordx4 a[12:15], v17, s[36:39], s61 offen sc1
    v_mfma_f32_16x16x32_bf16 v[104:107], v[208:211], a[108:111], v[104:107]
    v_cvt_pk_bf16_f32 v84, v108, v109
    v_mfma_f32_16x16x32_bf16 v[92:95], v[212:215], a[128:131], v[92:95]
    ds_read_b128 v[124:127], v47 offset:16384
    v_mul_f32 v80, v41, v116
    v_mul_f32 v81, v41, v117
    v_mfma_f32_16x16x32_bf16 v[96:99], v[212:215], a[132:135], v[96:99]
    ds_read_b128 v[128:131], v47 offset:17408
    v_fmac_f32 v118, v40, v66
    v_mfma_f32_16x16x32_bf16 v[100:103], v[212:215], a[136:139], v[100:103]
    ds_read_b128 v[132:135], v47 offset:18432
    buffer_load_dwordx4 a[32:35], v18, s[36:39], s61 offen sc1
    v_mfma_f32_16x16x32_bf16 v[104:107], v[212:215], a[140:143], v[104:107]
    ds_read_b128 v[136:139], v47 offset:19456
    v_fmac_f32 v119, v40, v67
    v_mfma_f32_16x16x32_bf16 v[92:95], v[216:219], a[160:163], v[92:95]
    v_exp_f32 v80, v80
    v_mul_f32 v116, v116, v118
    v_mfma_f32_16x16x32_bf16 v[96:99], v[216:219], a[164:167], v[96:99]
    buffer_load_dwordx4 a[36:39], v19, s[36:39], s61 offen sc1
    v_fma_f32 v80, v80, v42, v42
    v_mfma_f32_16x16x32_bf16 v[100:103], v[216:219], a[168:171], v[100:103]
    v_exp_f32 v81, v81
    v_mfma_f32_16x16x32_bf16 v[104:107], v[216:219], a[172:175], v[104:107]
    v_fma_f32 v81, v81, v42, v42
    v_mul_f32 v117, v117, v119
    v_mfma_f32_16x16x32_bf16 v[92:95], v[220:223], a[192:195], v[92:95]
    v_rcp_f32 v80, v80
    v_fmac_f32 v112, v36, v64
    v_mfma_f32_16x16x32_bf16 v[96:99], v[220:223], a[196:199], v[96:99]
    buffer_load_dwordx4 a[40:43], v16, s[36:39], s61 offen sc1
    v_mul_f32 v116, v116, v80
    v_mfma_f32_16x16x32_bf16 v[100:103], v[220:223], a[200:203], v[100:103]
    v_rcp_f32 v81, v81
    v_mfma_f32_16x16x32_bf16 v[104:107], v[220:223], a[204:207], v[104:107]
    v_mul_f32 v117, v117, v81
    s_waitcnt lgkmcnt(0)
    v_mfma_f32_16x16x32_bf16 v[124:127], v[168:171], a[16:19], v[124:127]
    s_add_u32 s61, s5, 4096
    buffer_load_dwordx4 a[44:47], v17, s[36:39], s61 offen sc1
    v_cvt_pk_bf16_f32 v86, v116, v117
    v_mfma_f32_16x16x32_bf16 v[128:131], v[168:171], a[20:23], v[128:131]
    s_nop 0
    v_permlane32_swap_b32 v84, v86
    v_fmac_f32 v113, v36, v65
    v_mfma_f32_16x16x32_bf16 v[132:135], v[168:171], a[24:27], v[132:135]
L_tf9:
    s_cbranch_execz L_tret
    ds_write_b128 v43, v[92:95] offset:0
    v_mfma_f32_16x16x32_bf16 v[136:139], v[168:171], a[28:31], v[136:139]
    v_mul_f32 v78, v37, v112
    v_mul_f32 v79, v37, v113
    v_mfma_f32_16x16x32_bf16 v[124:127], v[172:175], a[48:51], v[124:127]
    buffer_load_dwordx4 a[64:67], v18, s[36:39], s61 offen sc1
    v_exp_f32 v78, v78
    v_mfma_f32_16x16x32_bf16 v[128:131], v[172:175], a[52:55], v[128:131]
    v_exp_f32 v79, v79
    v_mfma_f32_16x16x32_bf16 v[132:135], v[172:175], a[56:59], v[132:135]
    ds_write_b128 v43, v[96:99] offset:1024
    v_mfma_f32_16x16x32_bf16 v[136:139], v[172:175], a[60:63], v[136:139]
    buffer_load_dwordx4 a[68:71], v19, s[36:39], s61 offen sc1
    v_fmac_f32 v114, v36, v66
    v_mfma_f32_16x16x32_bf16 v[124:127], v[176:179], a[80:83], v[124:127]
    v_fmac_f32 v115, v36, v67
    v_fma_f32 v78, v78, v38, v38
    v_fma_f32 v79, v79, v38, v38
    v_mfma_f32_16x16x32_bf16 v[128:131], v[176:179], a[84:87], v[128:131]
    v_rcp_f32 v78, v78
    v_mfma_f32_16x16x32_bf16 v[132:135], v[176:179], a[88:91], v[132:135]
    ds_write_b128 v43, v[100:103] offset:2048
    v_mfma_f32_16x16x32_bf16 v[136:139], v[176:179], a[92:95], v[136:139]
    buffer_load_dwordx4 a[72:75], v16, s[36:39], s61 offen sc1
    v_mul_f32 v112, v112, v114
    v_mfma_f32_16x16x32_bf16 v[124:127], v[180:183], a[112:115], v[124:127]
    v_rcp_f32 v79, v79
    v_mul_f32 v113, v113, v115
    v_mfma_f32_16x16x32_bf16 v[128:131], v[180:183], a[116:119], v[128:131]
    v_mul_f32 v112, v112, v78
    v_mul_f32 v113, v113, v79
    v_mfma_f32_16x16x32_bf16 v[132:135], v[180:183], a[120:123], v[132:135]
    ds_write_b128 v43, v[104:107] offset:3072
    v_mfma_f32_16x16x32_bf16 v[136:139], v[180:183], a[124:127], v[136:139]
    buffer_load_dwordx4 a[76:79], v4, s[28:31], s54 offen offset:2048
    v_cvt_pk_bf16_f32 v85, v112, v113
    v_mfma_f32_16x16x32_bf16 v[124:127], v[184:187], a[144:147], v[124:127]
    v_fmac_f32 v120, v44, v64
    v_fmac_f32 v121, v44, v65
    v_fmac_f32 v122, v44, v66
    v_mfma_f32_16x16x32_bf16 v[128:131], v[184:187], a[148:151], v[128:131]
    v_mul_f32 v82, v45, v120
    v_mul_f32 v83, v45, v121
    v_mfma_f32_16x16x32_bf16 v[132:135], v[184:187], a[152:155], v[132:135]
    buffer_load_dwordx4 a[96:99], v4, s[28:31], s55 offen offset:2048
    v_fmac_f32 v123, v44, v67
    v_mfma_f32_16x16x32_bf16 v[136:139], v[184:187], a[156:159], v[136:139]
    v_exp_f32 v82, v82
    v_mfma_f32_16x16x32_bf16 v[124:127], v[188:191], a[176:179], v[124:127]
    s_waitcnt lgkmcnt(0)
    s_barrier
    v_fma_f32 v82, v82, v46, v46
    v_mfma_f32_16x16x32_bf16 v[128:131], v[188:191], a[180:183], v[128:131]
    ds_read_b128 v[92:95], v47 offset:0
    buffer_load_dwordx4 a[100:103], v4, s[28:31], s56 offen offset:2048
    v_mfma_f32_16x16x32_bf16 v[132:135], v[188:191], a[184:187], v[132:135]
    ds_read_b128 v[96:99], v47 offset:1024
    v_mul_f32 v120, v120, v122
    v_mfma_f32_16x16x32_bf16 v[136:139], v[188:191], a[188:191], v[136:139]
    ds_read_b128 v[100:103], v47 offset:2048
    v_mul_f32 v121, v121, v123
    v_mfma_f32_16x16x32_bf16 v[124:127], v[192:195], a[208:211], v[124:127]
    ds_read_b128 v[104:107], v47 offset:3072
    v_exp_f32 v83, v83
    v_mfma_f32_16x16x32_bf16 v[128:131], v[192:195], a[212:215], v[128:131]
    s_add_u32 s61, s5, 32768
    buffer_load_dwordx4 a[104:107], v17, s[36:39], s61 offen sc1
    v_mfma_f32_16x16x32_bf16 v[132:135], v[192:195], a[216:219], v[132:135]
    v_fma_f32 v83, v83, v46, v46
    v_mfma_f32_16x16x32_bf16 v[136:139], v[192:195], a[220:223], v[136:139]
    s_waitcnt lgkmcnt(0)
    v_mfma_f32_16x16x32_bf16 v[92:95], v[196:199], a[16:19], v[92:95]
    buffer_load_dwordx4 a[108:111], v18, s[36:39], s61 offen sc1
    v_rcp_f32 v82, v82
    v_mfma_f32_16x16x32_bf16 v[96:99], v[196:199], a[20:23], v[96:99]
    v_rcp_f32 v83, v83
    v_mfma_f32_16x16x32_bf16 v[100:103], v[196:199], a[24:27], v[100:103]
    v_mul_f32 v120, v120, v82
    v_mul_f32 v121, v121, v83
    v_mfma_f32_16x16x32_bf16 v[104:107], v[196:199], a[28:31], v[104:107]
    v_cvt_pk_bf16_f32 v87, v120, v121
    v_fmac_f32 v124, v32, v68
    v_mfma_f32_16x16x32_bf16 v[92:95], v[200:203], a[48:51], v[92:95]
    buffer_load_dwordx4 a[128:131], v19, s[36:39], s61 offen sc1
    v_permlane32_swap_b32 v85, v87
    v_fmac_f32 v125, v32, v69
    v_mfma_f32_16x16x32_bf16 v[96:99], v[200:203], a[52:55], v[96:99]
    v_permlane16_swap_b32 v84, v85
    v_permlane16_swap_b32 v86, v87
    v_mfma_f32_16x16x32_bf16 v[100:103], v[200:203], a[56:59], v[100:103]
    buffer_store_dwordx4 v[84:87], v12, s[20:23], s66 offen sc1
    v_mul_f32 v76, v33, v124
    v_mfma_f32_16x16x32_bf16 v[104:107], v[200:203], a[60:63], v[104:107]
    v_mul_f32 v77, v33, v125
    v_fmac_f32 v126, v32, v70
    v_mfma_f32_16x16x32_bf16 v[92:95], v[204:207], a[80:83], v[92:95]
    v_exp_f32 v76, v76
    v_fmac_f32 v127, v32, v71
    v_mfma_f32_16x16x32_bf16 v[96:99], v[204:207], a[84:87], v[96:99]
    v_exp_f32 v77, v77
    v_mfma_f32_16x16x32_bf16 v[100:103], v[204:207], a[88:91], v[100:103]
    v_fma_f32 v76, v76, v34, v34
    v_fma_f32 v77, v77, v34, v34
    v_mfma_f32_16x16x32_bf16 v[104:107], v[204:207], a[92:95], v[104:107]
    v_rcp_f32 v76, v76
    v_mfma_f32_16x16x32_bf16 v[92:95], v[208:211], a[112:115], v[92:95]
    v_rcp_f32 v77, v77
    v_mul_f32 v124, v124, v126
    v_mfma_f32_16x16x32_bf16 v[96:99], v[208:211], a[116:119], v[96:99]
    v_mul_f32 v125, v125, v127
    v_mul_f32 v124, v124, v76
    v_mfma_f32_16x16x32_bf16 v[100:103], v[208:211], a[120:123], v[100:103]
    buffer_load_dwordx4 a[132:135], v16, s[36:39], s61 offen sc1
    v_mul_f32 v125, v125, v77
    v_mfma_f32_16x16x32_bf16 v[104:107], v[208:211], a[124:127], v[104:107]
    v_cvt_pk_bf16_f32 v88, v124, v125
    v_fmac_f32 v132, v40, v68
    v_mfma_f32_16x16x32_bf16 v[92:95], v[212:215], a[144:147], v[92:95]
    v_fmac_f32 v133, v40, v69
    v_mul_f32 v80, v41, v132
    v_fmac_f32 v134, v40, v70
    v_mfma_f32_16x16x32_bf16 v[96:99], v[212:215], a[148:151], v[96:99]
    v_mul_f32 v81, v41, v133
    v_fmac_f32 v135, v40, v71
    v_mfma_f32_16x16x32_bf16 v[100:103], v[212:215], a[152:155], v[100:103]
    buffer_load_dwordx4 a[136:139], v4, s[28:31], 0 offen offset:3072
    v_mul_f32 v132, v132, v134
    v_mfma_f32_16x16x32_bf16 v[104:107], v[212:215], a[156:159], v[104:107]
    v_exp_f32 v80, v80
    v_mfma_f32_16x16x32_bf16 v[92:95], v[216:219], a[176:179], v[92:95]
    v_exp_f32 v81, v81
    v_fma_f32 v80, v80, v42, v42
    v_mfma_f32_16x16x32_bf16 v[96:99], v[216:219], a[180:183], v[96:99]
    buffer_load_dwordx4 a[140:143], v4, s[28:31], s50 offen offset:3072
    v_fma_f32 v81, v81, v42, v42
    v_mfma_f32_16x16x32_bf16 v[100:103], v[216:219], a[184:187], v[100:103]
    v_rcp_f32 v80, v80
    v_mfma_f32_16x16x32_bf16 v[104:107], v[216:219], a[188:191], v[104:107]
    v_rcp_f32 v81, v81
    v_mfma_f32_16x16x32_bf16 v[92:95], v[220:223], a[208:211], v[92:95]
    v_mul_f32 v133, v133, v135
    v_mul_f32 v132, v132, v80
    v_fmac_f32 v128, v36, v68
    v_mfma_f32_16x16x32_bf16 v[96:99], v[220:223], a[212:215], v[96:99]
    buffer_load_dwordx4 a[160:163], v4, s[28:31], s51 offen offset:3072
    v_mul_f32 v133, v133, v81
    v_mfma_f32_16x16x32_bf16 v[100:103], v[220:223], a[216:219], v[100:103]
    v_cvt_pk_bf16_f32 v90, v132, v133
    v_fmac_f32 v129, v36, v69
    v_mfma_f32_16x16x32_bf16 v[104:107], v[220:223], a[220:223], v[104:107]
    v_permlane32_swap_b32 v88, v90
    v_mul_f32 v78, v37, v128
    buffer_load_dwordx4 a[164:167], v4, s[28:31], s52 offen offset:3072
    s_add_u32 s61, s5, 8192
    buffer_load_dwordx4 a[168:171], v17, s[36:39], s61 offen sc1
    buffer_load_dwordx4 a[172:175], v18, s[36:39], s61 offen sc1
    buffer_load_dwordx4 a[192:195], v19, s[36:39], s61 offen sc1
    v_mul_f32 v79, v37, v129
    v_fmac_f32 v130, v36, v70
    v_exp_f32 v78, v78
    v_exp_f32 v79, v79
    v_fmac_f32 v131, v36, v71
    v_fma_f32 v78, v78, v38, v38
    v_fma_f32 v79, v79, v38, v38
    v_mul_f32 v128, v128, v130
L_tf10:
    s_cbranch_execz L_tret
    v_rcp_f32 v78, v78
    v_rcp_f32 v79, v79
    buffer_load_dwordx4 a[196:199], v16, s[36:39], s61 offen sc1
    v_mul_f32 v129, v129, v131
    v_mul_f32 v128, v128, v78
    v_mul_f32 v129, v129, v79
    v_fmac_f32 v136, v44, v68
    v_cvt_pk_bf16_f32 v89, v128, v129
    v_fmac_f32 v137, v44, v69
    v_mul_f32 v82, v45, v136
    v_mul_f32 v83, v45, v137
    v_exp_f32 v82, v82
    v_exp_f32 v83, v83
    v_fmac_f32 v138, v44, v70
    v_fmac_f32 v139, v44, v71
    buffer_load_dwordx4 a[200:203], v4, s[28:31], s53 offen offset:3072
    v_fma_f32 v82, v82, v46, v46
    v_fma_f32 v83, v83, v46, v46
    v_rcp_f32 v82, v82
    v_rcp_f32 v83, v83
    v_mul_f32 v136, v136, v138
    v_mul_f32 v137, v137, v139
    v_mul_f32 v136, v136, v82
    v_mul_f32 v137, v137, v83
    v_cvt_pk_bf16_f32 v91, v136, v137
    v_fmac_f32 v92, v32, v72
    s_nop 0
    v_permlane32_swap_b32 v89, v91
    v_fmac_f32 v93, v32, v73
    buffer_load_dwordx4 a[204:207], v4, s[28:31], s54 offen offset:3072
    v_permlane16_swap_b32 v88, v89
    v_permlane16_swap_b32 v90, v91
    v_fmac_f32 v96, v36, v72
    v_fmac_f32 v97, v36, v73
    buffer_store_dwordx4 v[88:91], v13, s[20:23], s66 offen sc1
    v_fmac_f32 v100, v40, v72
    v_fmac_f32 v101, v40, v73
    v_fmac_f32 v104, v44, v72
    v_fmac_f32 v105, v44, v73
    v_mul_f32 v76, v33, v92
    v_mul_f32 v77, v33, v93
    v_mul_f32 v78, v37, v96
    v_mul_f32 v79, v37, v97
    buffer_load_dwordx4 a[16:19], v4, s[28:31], s55 offen offset:3072
    v_mul_f32 v80, v41, v100
    v_mul_f32 v81, v41, v101
    v_mul_f32 v82, v45, v104
    v_mul_f32 v83, v45, v105
    v_exp_f32 v76, v76
    v_exp_f32 v77, v77
    v_exp_f32 v78, v78
    v_exp_f32 v79, v79
    v_exp_f32 v80, v80
    v_exp_f32 v81, v81
    buffer_load_dwordx4 a[20:23], v4, s[28:31], s56 offen offset:3072
    v_exp_f32 v82, v82
    v_exp_f32 v83, v83
    v_fmac_f32 v94, v32, v74
    v_fmac_f32 v95, v32, v75
    v_fmac_f32 v98, v36, v74
    v_fmac_f32 v99, v36, v75
    v_fmac_f32 v102, v40, v74
    v_fmac_f32 v103, v40, v75
    v_fmac_f32 v106, v44, v74
    v_fmac_f32 v107, v44, v75
    v_fma_f32 v76, v76, v34, v34
    v_fma_f32 v77, v77, v34, v34
    s_add_u32 s61, s5, 36864
    buffer_load_dwordx4 a[24:27], v17, s[36:39], s61 offen sc1
    v_fma_f32 v78, v78, v38, v38
    v_fma_f32 v79, v79, v38, v38
    v_fma_f32 v80, v80, v42, v42
    v_fma_f32 v81, v81, v42, v42
    v_fma_f32 v82, v82, v46, v46
    v_fma_f32 v83, v83, v46, v46
    v_rcp_f32 v76, v76
    v_rcp_f32 v77, v77
    v_rcp_f32 v78, v78
    v_rcp_f32 v79, v79
    v_rcp_f32 v80, v80
    v_rcp_f32 v81, v81
    v_rcp_f32 v82, v82
    v_rcp_f32 v83, v83
    v_mul_f32 v92, v92, v94
    v_mul_f32 v93, v93, v95
    v_mul_f32 v96, v96, v98
    v_mul_f32 v97, v97, v99
    v_mul_f32 v100, v100, v102
    v_mul_f32 v101, v101, v103
    v_mul_f32 v104, v104, v106
    v_mul_f32 v105, v105, v107
    v_mul_f32 v92, v92, v76
    v_mul_f32 v93, v93, v77
    v_mul_f32 v96, v96, v78
    v_mul_f32 v97, v97, v79
    v_mul_f32 v100, v100, v80
    v_mul_f32 v101, v101, v81
    v_mul_f32 v104, v104, v82
    v_mul_f32 v105, v105, v83
    v_cvt_pk_bf16_f32 v84, v92, v93
    v_cvt_pk_bf16_f32 v86, v100, v101
    v_cvt_pk_bf16_f32 v85, v96, v97
    v_cvt_pk_bf16_f32 v87, v104, v105
    buffer_load_dwordx4 a[28:31], v18, s[36:39], s61 offen sc1
    v_permlane32_swap_b32 v84, v86
    v_permlane32_swap_b32 v85, v87
    s_nop 1
    v_permlane16_swap_b32 v84, v85
    v_permlane16_swap_b32 v86, v87
    v_lshlrev_b32 v92, 16, v24
    v_and_b32 v93, 0xffff0000, v24
    buffer_store_dwordx4 v[84:87], v14, s[20:23], s66 offen sc1
    s_cmp_eq_u32 s58, 7
    s_cbranch_scc1 L_ff_fin
    s_waitcnt vmcnt(36)
    v_mfma_f32_16x16x32_bf16 v[108:111], a[252:255], v[160:163], 0
    v_lshlrev_b32 v94, 16, v25
    v_and_b32 v95, 0xffff0000, v25
    v_mfma_f32_16x16x32_bf16 v[112:115], a[248:251], v[160:163], 0
    v_lshlrev_b32 v96, 16, v26
    v_and_b32 v97, 0xffff0000, v26
    v_mfma_f32_16x16x32_bf16 v[116:119], a[244:247], v[160:163], 0
    s_waitcnt vmcnt(34)
    buffer_load_dwordx4 a[48:51], v19, s[36:39], s61 offen sc1
    v_mfma_f32_16x16x32_bf16 v[120:123], a[240:243], v[160:163], 0
    v_lshlrev_b32 v98, 16, v27
    v_and_b32 v99, 0xffff0000, v27
    v_mfma_f32_16x16x32_bf16 v[124:127], a[252:255], a[0:3], 0
    v_lshlrev_b32 v100, 16, v8
    v_and_b32 v101, 0xffff0000, v8
    v_mfma_f32_16x16x32_bf16 v[128:131], a[248:251], a[0:3], 0
    v_lshlrev_b32 v102, 16, v9
    v_and_b32 v103, 0xffff0000, v9
    v_mfma_f32_16x16x32_bf16 v[132:135], a[244:247], a[0:3], 0
    s_waitcnt vmcnt(34)
    v_lshlrev_b32 v104, 16, v10
    v_mfma_f32_16x16x32_bf16 v[136:139], a[240:243], a[0:3], 0
    buffer_load_dwordx4 a[52:55], v16, s[36:39], s61 offen sc1
    v_and_b32 v105, 0xffff0000, v10
    v_mfma_f32_16x16x32_bf16 v[48:51], a[252:255], a[4:7], 0
    v_lshlrev_b32 v106, 16, v11
    v_and_b32 v107, 0xffff0000, v11
    v_mfma_f32_16x16x32_bf16 v[52:55], a[248:251], a[4:7], 0
    v_and_b32 v76, 15, v1
    v_bfe_u32 v77, v1, 4, 1
    v_mfma_f32_16x16x32_bf16 v[56:59], a[244:247], a[4:7], 0
    s_waitcnt vmcnt(33)
    v_mul_u32_u24 v76, 896, v76
    v_mfma_f32_16x16x32_bf16 v[60:63], a[240:243], a[4:7], 0
    s_add_u32 s61, s5, 12288
    buffer_load_dwordx4 a[56:59], v17, s[36:39], s61 offen sc1
    v_mfma_f32_16x16x32_bf16 v[108:111], a[236:239], a[12:15], v[108:111]
    v_lshrrev_b32 v78, 5, v1
    v_lshl_add_u32 v76, v77, 5, v76
    v_mfma_f32_16x16x32_bf16 v[112:115], a[232:235], a[12:15], v[112:115]
    v_lshl_add_u32 v76, v78, 4, v76
    s_mov_b64 s[24:25], s[100:101]
    v_mfma_f32_16x16x32_bf16 v[116:119], a[228:231], a[12:15], v[116:119]
    s_waitcnt vmcnt(33)
    s_mov_b32 s26, 13568
    v_mfma_f32_16x16x32_bf16 v[120:123], a[224:227], a[12:15], v[120:123]
    s_add_u32 s61, s5, 40960
    buffer_load_dwordx4 a[60:63], v17, s[36:39], s61 offen sc1
    v_mfma_f32_16x16x32_bf16 v[124:127], a[236:239], a[32:35], v[124:127]
    ds_read_b128 a[80:83], v4 offset:0
    v_mfma_f32_16x16x32_bf16 v[128:131], a[232:235], a[32:35], v[128:131]
    ds_read_b128 a[84:87], v4 offset:3072
    v_mfma_f32_16x16x32_bf16 v[132:135], a[228:231], a[32:35], v[132:135]
    ds_read_b128 a[88:91], v4 offset:6144
    v_mfma_f32_16x16x32_bf16 v[136:139], a[224:227], a[32:35], v[136:139]
    ds_read_b128 a[92:95], v4 offset:9216
    v_mfma_f32_16x16x32_bf16 v[92:95], a[252:255], a[8:11], v[92:95]
    s_add_u32 s61, s5, 12288
    buffer_load_dwordx4 a[112:115], v18, s[36:39], s61 offen sc1
    v_mfma_f32_16x16x32_bf16 v[96:99], a[248:251], a[8:11], v[96:99]
    ds_read_b128 a[116:119], v4 offset:12288
    v_mfma_f32_16x16x32_bf16 v[100:103], a[244:247], a[8:11], v[100:103]
    s_waitcnt vmcnt(34)
    ds_read_b128 a[120:123], v4 offset:15360
    v_mfma_f32_16x16x32_bf16 v[104:107], a[240:243], a[8:11], v[104:107]
    ds_read_b128 a[124:127], v4 offset:18432
    v_mfma_f32_16x16x32_bf16 v[48:51], a[236:239], a[36:39], v[48:51]
    s_add_u32 s61, s5, 40960
    buffer_load_dwordx4 a[144:147], v18, s[36:39], s61 offen sc1
    v_mfma_f32_16x16x32_bf16 v[52:55], a[232:235], a[36:39], v[52:55]
    ds_read_b128 a[148:151], v4 offset:21504
    v_mfma_f32_16x16x32_bf16 v[56:59], a[228:231], a[36:39], v[56:59]
    s_waitcnt vmcnt(34)
    ds_read_b128 a[152:155], v4 offset:24576
    v_mfma_f32_16x16x32_bf16 v[60:63], a[224:227], a[36:39], v[60:63]
L_tf11:
    s_cbranch_execz L_tret
    ds_read_b128 a[156:159], v4 offset:27648
    v_mfma_f32_16x16x32_bf16 v[92:95], a[236:239], a[40:43], v[92:95]
    ds_read_b128 a[176:179], v4 offset:30720
    v_mfma_f32_16x16x32_bf16 v[96:99], a[232:235], a[40:43], v[96:99]
    s_add_u32 s61, s5, 12288
    buffer_load_dwordx4 a[180:183], v19, s[36:39], s61 offen sc1
    v_mfma_f32_16x16x32_bf16 v[100:103], a[228:231], a[40:43], v[100:103]
    s_waitcnt vmcnt(34)
    ds_read_b128 a[184:187], v4 offset:33792
    v_mfma_f32_16x16x32_bf16 v[104:107], a[224:227], a[40:43], v[104:107]
    ds_read_b128 a[188:191], v4 offset:36864
    v_mfma_f32_16x16x32_bf16 v[108:111], v[252:255], a[44:47], v[108:111]
    ds_read_b128 a[208:211], v4 offset:39936
    v_mfma_f32_16x16x32_bf16 v[112:115], v[224:227], a[44:47], v[112:115]
    s_add_u32 s61, s5, 40960
    buffer_load_dwordx4 a[212:215], v19, s[36:39], s61 offen sc1
    v_mfma_f32_16x16x32_bf16 v[116:119], v[228:231], a[44:47], v[116:119]
    s_waitcnt vmcnt(34)
    ds_read_b128 a[216:219], v4 offset:43008
    v_mfma_f32_16x16x32_bf16 v[120:123], v[232:235], a[44:47], v[120:123]
    ds_read_b128 a[220:223], v4 offset:46080
    v_mfma_f32_16x16x32_bf16 v[124:127], v[252:255], a[64:67], v[124:127]
    ds_read_b128 a[0:3], v7 offset:0
    v_mfma_f32_16x16x32_bf16 v[128:131], v[224:227], a[64:67], v[128:131]
    s_add_u32 s61, s5, 12288
    buffer_load_dwordx4 a[4:7], v16, s[36:39], s61 offen sc1
    v_mfma_f32_16x16x32_bf16 v[132:135], v[228:231], a[64:67], v[132:135]
    s_waitcnt vmcnt(34)
    ds_read_b128 a[12:15], v7 offset:3072
    v_mfma_f32_16x16x32_bf16 v[136:139], v[232:235], a[64:67], v[136:139]
    ds_read_b128 a[32:35], v7 offset:6144
    v_mfma_f32_16x16x32_bf16 v[48:51], v[252:255], a[68:71], v[48:51]
    ds_read_b128 a[252:255], v7 offset:9216
    v_mfma_f32_16x16x32_bf16 v[52:55], v[224:227], a[68:71], v[52:55]
    ds_read_b128 a[248:251], v7 offset:12288
    v_mfma_f32_16x16x32_bf16 v[56:59], v[228:231], a[68:71], v[56:59]
    s_waitcnt vmcnt(33)
    s_add_u32 s61, s5, 40960
    buffer_load_dwordx4 a[244:247], v16, s[36:39], s61 offen sc1
    v_mfma_f32_16x16x32_bf16 v[60:63], v[232:235], a[68:71], v[60:63]
    ds_read_b128 a[240:243], v7 offset:15360
    v_mfma_f32_16x16x32_bf16 v[92:95], v[252:255], a[72:75], v[92:95]
    ds_read_b128 a[8:11], v7 offset:18432
    v_mfma_f32_16x16x32_bf16 v[96:99], v[224:227], a[72:75], v[96:99]
    ds_read_b128 a[36:39], v7 offset:21504
    v_mfma_f32_16x16x32_bf16 v[100:103], v[228:231], a[72:75], v[100:103]
    s_waitcnt vmcnt(30)
    ds_read_b128 a[236:239], v7 offset:24576
    v_mfma_f32_16x16x32_bf16 v[104:107], v[232:235], a[72:75], v[104:107]
    ds_read_b128 a[232:235], v7 offset:27648
    v_mfma_f32_16x16x32_bf16 v[108:111], v[236:239], a[104:107], v[108:111]
    ds_read_b128 a[228:231], v7 offset:30720
    v_mfma_f32_16x16x32_bf16 v[112:115], v[240:243], a[104:107], v[112:115]
    ds_read_b128 a[224:227], v7 offset:33792
    v_mfma_f32_16x16x32_bf16 v[116:119], v[244:247], a[104:107], v[116:119]
    s_waitcnt vmcnt(29)
    ds_read_b128 a[40:43], v7 offset:36864
    v_mfma_f32_16x16x32_bf16 v[120:123], v[248:251], a[104:107], v[120:123]
    ds_read_b128 a[44:47], v7 offset:39936
    v_mfma_f32_16x16x32_bf16 v[124:127], v[236:239], a[108:111], v[124:127]
    v_mfma_f32_16x16x32_bf16 v[128:131], v[240:243], a[108:111], v[128:131]
    v_mfma_f32_16x16x32_bf16 v[132:135], v[244:247], a[108:111], v[132:135]
    s_waitcnt vmcnt(28)
    v_mfma_f32_16x16x32_bf16 v[136:139], v[248:251], a[108:111], v[136:139]
    s_mov_b32 s61, 16384
    buffer_load_dwordx4 v[164:167], v16, s[36:39], s61 offen sc1
    v_mfma_f32_16x16x32_bf16 v[48:51], v[236:239], a[128:131], v[48:51]
    ds_read_b128 a[64:67], v7 offset:43008
    v_mfma_f32_16x16x32_bf16 v[52:55], v[240:243], a[128:131], v[52:55]
    v_mfma_f32_16x16x32_bf16 v[56:59], v[244:247], a[128:131], v[56:59]
    s_waitcnt vmcnt(27)
    v_mfma_f32_16x16x32_bf16 v[60:63], v[248:251], a[128:131], v[60:63]
    s_mov_b32 s61, 45056
    buffer_load_dwordx4 v[168:171], v16, s[36:39], s61 offen sc1
    v_mfma_f32_16x16x32_bf16 v[92:95], v[236:239], a[132:135], v[92:95]
    ds_read_b128 a[68:71], v7 offset:46080
    v_mfma_f32_16x16x32_bf16 v[96:99], v[240:243], a[132:135], v[96:99]
    ds_read_b128 a[72:75], v4 offset:1024
    v_mfma_f32_16x16x32_bf16 v[100:103], v[244:247], a[132:135], v[100:103]
    s_waitcnt vmcnt(23)
    ds_read_b128 a[104:107], v4 offset:4096
    v_mfma_f32_16x16x32_bf16 v[104:107], v[248:251], a[132:135], v[104:107]
    ds_read_b128 a[108:111], v4 offset:7168
    v_mfma_f32_16x16x32_bf16 v[108:111], v[140:143], a[168:171], v[108:111]
    s_mov_b32 s61, 73728
    buffer_load_dwordx4 v[172:175], v16, s[36:39], s61 offen sc1
    v_mfma_f32_16x16x32_bf16 v[112:115], v[144:147], a[168:171], v[112:115]
    ds_read_b128 a[128:131], v4 offset:10240
    v_mfma_f32_16x16x32_bf16 v[116:119], v[148:151], a[168:171], v[116:119]
    s_waitcnt vmcnt(23)
    ds_read_b128 a[132:135], v4 offset:13312
    v_mfma_f32_16x16x32_bf16 v[120:123], v[152:155], a[168:171], v[120:123]
    ds_read_b128 a[168:171], v4 offset:16384
    v_mfma_f32_16x16x32_bf16 v[124:127], v[140:143], a[172:175], v[124:127]
    s_mov_b32 s61, 102400
    buffer_load_dwordx4 v[176:179], v16, s[36:39], s61 offen sc1
    v_mfma_f32_16x16x32_bf16 v[128:131], v[144:147], a[172:175], v[128:131]
    v_mfma_f32_16x16x32_bf16 v[132:135], v[148:151], a[172:175], v[132:135]
    s_waitcnt vmcnt(23)
    v_mfma_f32_16x16x32_bf16 v[136:139], v[152:155], a[172:175], v[136:139]
    ds_read_b128 a[172:175], v4 offset:19456
    v_mfma_f32_16x16x32_bf16 v[48:51], v[140:143], a[192:195], v[48:51]
    v_mfma_f32_16x16x32_bf16 v[52:55], v[144:147], a[192:195], v[52:55]
    v_mfma_f32_16x16x32_bf16 v[56:59], v[148:151], a[192:195], v[56:59]
    s_waitcnt vmcnt(22)
    v_mfma_f32_16x16x32_bf16 v[60:63], v[152:155], a[192:195], v[60:63]
    ds_read_b128 a[192:195], v4 offset:22528
L_tf12:
    s_cbranch_execz L_tret
    v_mfma_f32_16x16x32_bf16 v[92:95], v[140:143], a[196:199], v[92:95]
    ds_read_b128 v[180:183], v4 offset:25600
    v_mfma_f32_16x16x32_bf16 v[96:99], v[144:147], a[196:199], v[96:99]
    ds_read_b128 v[184:187], v4 offset:28672
    v_mfma_f32_16x16x32_bf16 v[100:103], v[148:151], a[196:199], v[100:103]
    ds_read_b128 v[188:191], v4 offset:31744
    v_mfma_f32_16x16x32_bf16 v[104:107], v[152:155], a[196:199], v[104:107]
    ds_read_b128 a[196:199], v4 offset:34816
    ds_read_b128 v[192:195], v4 offset:37888
    s_mov_b32 s61, 131072
    buffer_load_dwordx4 v[196:199], v16, s[36:39], s61 offen sc1
    s_mov_b32 s61, 159744
    buffer_load_dwordx4 v[200:203], v16, s[36:39], s61 offen sc1
    s_mov_b32 s61, 188416
    buffer_load_dwordx4 v[204:207], v16, s[36:39], s61 offen sc1
    s_waitcnt vmcnt(19)
    v_mfma_f32_16x16x32_bf16 v[108:111], v[156:159], a[24:27], v[108:111]
    v_mfma_f32_16x16x32_bf16 v[112:115], a[76:79], a[24:27], v[112:115]
    v_mfma_f32_16x16x32_bf16 v[116:119], a[96:99], a[24:27], v[116:119]
    s_waitcnt vmcnt(18)
    v_mfma_f32_16x16x32_bf16 v[120:123], a[100:103], a[24:27], v[120:123]
    ds_read_b128 a[24:27], v4 offset:40960
    v_mfma_f32_16x16x32_bf16 v[124:127], v[156:159], a[28:31], v[124:127]
    v_mfma_f32_16x16x32_bf16 v[128:131], a[76:79], a[28:31], v[128:131]
    s_mov_b32 s61, 217088
    buffer_load_dwordx4 v[208:211], v16, s[36:39], s61 offen sc1
    v_mfma_f32_16x16x32_bf16 v[132:135], a[96:99], a[28:31], v[132:135]
    v_mfma_f32_16x16x32_bf16 v[136:139], a[100:103], a[28:31], v[136:139]
    ds_read_b128 a[28:31], v4 offset:44032
    s_mov_b32 s61, 20480
    buffer_load_dwordx4 v[212:215], v16, s[36:39], s61 offen sc1
    s_mov_b32 s61, 49152
    buffer_load_dwordx4 v[216:219], v16, s[36:39], s61 offen sc1
    s_mov_b32 s61, 77824
    buffer_load_dwordx4 v[220:223], v16, s[36:39], s61 offen sc1
    s_mov_b32 s61, 106496
    buffer_load_dwordx4 v[160:163], v16, s[36:39], s61 offen sc1
    s_mov_b32 s61, 135168
    buffer_load_dwordx4 v[252:255], v16, s[36:39], s61 offen sc1
    s_waitcnt vmcnt(22)
    v_mfma_f32_16x16x32_bf16 v[48:51], v[156:159], a[48:51], v[48:51]
    v_mfma_f32_16x16x32_bf16 v[52:55], a[76:79], a[48:51], v[52:55]
    v_mfma_f32_16x16x32_bf16 v[56:59], a[96:99], a[48:51], v[56:59]
    s_waitcnt vmcnt(21)
    v_mfma_f32_16x16x32_bf16 v[60:63], a[100:103], a[48:51], v[60:63]
    ds_read_b128 a[48:51], v4 offset:47104
    v_mfma_f32_16x16x32_bf16 v[92:95], v[156:159], a[52:55], v[92:95]
    s_mov_b32 s61, 163840
    buffer_load_dwordx4 v[224:227], v16, s[36:39], s61 offen sc1
    v_mfma_f32_16x16x32_bf16 v[96:99], a[76:79], a[52:55], v[96:99]
    ds_read_b128 a[76:79], v7 offset:1024
    v_mfma_f32_16x16x32_bf16 v[100:103], a[96:99], a[52:55], v[100:103]
    s_waitcnt vmcnt(21)
    ds_read_b128 a[96:99], v7 offset:4096
    v_mfma_f32_16x16x32_bf16 v[104:107], a[100:103], a[52:55], v[104:107]
    ds_read_b128 a[100:103], v7 offset:7168
    v_mfma_f32_16x16x32_bf16 v[108:111], a[136:139], a[56:59], v[108:111]
    ds_read_b128 a[52:55], v7 offset:10240
    v_mfma_f32_16x16x32_bf16 v[112:115], a[140:143], a[56:59], v[112:115]
    s_mov_b32 s61, 192512
    buffer_load_dwordx4 v[228:231], v16, s[36:39], s61 offen sc1
    v_mfma_f32_16x16x32_bf16 v[116:119], a[160:163], a[56:59], v[116:119]
    s_waitcnt vmcnt(21)
    ds_read_b128 v[232:235], v7 offset:13312
    v_mfma_f32_16x16x32_bf16 v[120:123], a[164:167], a[56:59], v[120:123]
    ds_read_b128 a[56:59], v7 offset:16384
    v_mfma_f32_16x16x32_bf16 v[108:111], a[200:203], a[60:63], v[108:111]
    v_mfma_f32_16x16x32_bf16 v[112:115], a[204:207], a[60:63], v[112:115]
    s_mov_b32 s61, 221184
    buffer_load_dwordx4 v[236:239], v16, s[36:39], s61 offen sc1
    v_mfma_f32_16x16x32_bf16 v[116:119], a[16:19], a[60:63], v[116:119]
    s_waitcnt vmcnt(21)
    v_mfma_f32_16x16x32_bf16 v[120:123], a[20:23], a[60:63], v[120:123]
    s_nop 1
    ds_write_b128 v17, v[108:111] offset:0
    ds_read_b128 a[60:63], v7 offset:19456
    v_mfma_f32_16x16x32_bf16 v[124:127], a[136:139], a[112:115], v[124:127]
    v_mfma_f32_16x16x32_bf16 v[128:131], a[140:143], a[112:115], v[128:131]
    ds_write_b128 v17, v[112:115] offset:4096
    v_mfma_f32_16x16x32_bf16 v[132:135], a[160:163], a[112:115], v[132:135]
    s_waitcnt vmcnt(20)
    s_mov_b32 s61, 24576
    buffer_load_dwordx4 v[240:243], v16, s[36:39], s61 offen sc1
    v_mfma_f32_16x16x32_bf16 v[136:139], a[164:167], a[112:115], v[136:139]
    ds_write_b128 v17, v[116:119] offset:8192
    ds_read_b128 a[112:115], v7 offset:22528
    v_mfma_f32_16x16x32_bf16 v[124:127], a[200:203], a[144:147], v[124:127]
    v_mfma_f32_16x16x32_bf16 v[128:131], a[204:207], a[144:147], v[128:131]
    ds_write_b128 v17, v[120:123] offset:12288
    v_mfma_f32_16x16x32_bf16 v[132:135], a[16:19], a[144:147], v[132:135]
    s_waitcnt vmcnt(20)
    s_mov_b32 s61, 53248
    buffer_load_dwordx4 v[244:247], v16, s[36:39], s61 offen sc1
    v_mfma_f32_16x16x32_bf16 v[136:139], a[20:23], a[144:147], v[136:139]
    s_nop 0
    ds_write_b128 v18, v[124:127] offset:32768
    ds_read_b128 a[144:147], v7 offset:25600
    v_mfma_f32_16x16x32_bf16 v[48:51], a[136:139], a[180:183], v[48:51]
    v_mfma_f32_16x16x32_bf16 v[52:55], a[140:143], a[180:183], v[52:55]
    ds_write_b128 v18, v[128:131] offset:36864
    v_mfma_f32_16x16x32_bf16 v[56:59], a[160:163], a[180:183], v[56:59]
    s_waitcnt vmcnt(20)
    s_mov_b32 s61, 81920
    buffer_load_dwordx4 v[248:251], v16, s[36:39], s61 offen sc1
    v_mfma_f32_16x16x32_bf16 v[60:63], a[164:167], a[180:183], v[60:63]
    ds_write_b128 v18, v[132:135] offset:40960
    ds_read_b128 a[180:183], v7 offset:28672
    v_mfma_f32_16x16x32_bf16 v[48:51], a[200:203], a[212:215], v[48:51]
    v_mfma_f32_16x16x32_bf16 v[52:55], a[204:207], a[212:215], v[52:55]
    ds_write_b128 v18, v[136:139] offset:45056
    v_mfma_f32_16x16x32_bf16 v[56:59], a[16:19], a[212:215], v[56:59]
    s_waitcnt vmcnt(20)
    s_mov_b32 s61, 110592
    buffer_load_dwordx4 v[140:143], v16, s[36:39], s61 offen sc1
    v_mfma_f32_16x16x32_bf16 v[60:63], a[20:23], a[212:215], v[60:63]
    s_nop 0
    ds_write_b128 v19, v[48:51] offset:49152
    ds_read_b128 a[212:215], v7 offset:31744
    v_mfma_f32_16x16x32_bf16 v[92:95], a[136:139], a[4:7], v[92:95]
    ds_read_b128 a[136:139], v7 offset:34816
    v_mfma_f32_16x16x32_bf16 v[96:99], a[140:143], a[4:7], v[96:99]
    ds_write_b128 v19, v[52:55] offset:53248
    ds_read_b128 a[140:143], v7 offset:37888
    v_mfma_f32_16x16x32_bf16 v[100:103], a[160:163], a[4:7], v[100:103]
    s_waitcnt vmcnt(20)
    s_mov_b32 s61, 139264
    buffer_load_dwordx4 v[144:147], v16, s[36:39], s61 offen sc1
    v_mfma_f32_16x16x32_bf16 v[104:107], a[164:167], a[4:7], v[104:107]
    ds_write_b128 v19, v[56:59] offset:57344
    ds_read_b128 a[160:163], v7 offset:40960
    v_mfma_f32_16x16x32_bf16 v[92:95], a[200:203], a[244:247], v[92:95]
    ds_read_b128 a[164:167], v7 offset:44032
    v_mfma_f32_16x16x32_bf16 v[96:99], a[204:207], a[244:247], v[96:99]
    ds_write_b128 v19, v[60:63] offset:61440
    ds_read_b128 a[4:7], v7 offset:47104
    v_mfma_f32_16x16x32_bf16 v[100:103], a[16:19], a[244:247], v[100:103]
    s_waitcnt vmcnt(20) lgkmcnt(14)
    v_cmp_eq_u32 vcc, -1, v164
    v_mfma_f32_16x16x32_bf16 v[104:107], a[20:23], a[244:247], v[104:107]
    s_mov_b32 s61, 167936
    buffer_load_dwordx4 v[148:151], v16, s[36:39], s61 offen sc1
    s_cbranch_vccnz L_ff_rt0
    v_mfma_f32_16x16x32_bf16 v[92:95], a[80:83], v[164:167], v[92:95]
    ds_read_b128 a[200:203], v4 offset:2048
    v_mfma_f32_16x16x32_bf16 v[96:99], a[84:87], v[164:167], v[96:99]
L_tf13:
    s_cbranch_execz L_tret
    s_waitcnt lgkmcnt(2)
    s_barrier
    v_mfma_f32_16x16x32_bf16 v[100:103], a[88:91], v[164:167], v[100:103]
    s_waitcnt vmcnt(20)
    v_cmp_eq_u32 vcc, -1, v168
    v_mfma_f32_16x16x32_bf16 v[104:107], a[92:95], v[164:167], v[104:107]
    s_mov_b32 s61, 196608
    buffer_load_dwordx4 v[152:155], v16, s[36:39], s61 offen sc1
L_ff_rb0:
    s_cbranch_vccnz L_ff_rt1
    v_mfma_f32_16x16x32_bf16 v[92:95], a[116:119], v[168:171], v[92:95]
    ds_read_b128 v[108:111], v16 offset:0
    ds_read_b128 v[124:127], v16 offset:32768
    v_mfma_f32_16x16x32_bf16 v[96:99], a[120:123], v[168:171], v[96:99]
    ds_read_b128 v[48:51], v16 offset:49152
    ds_read_b128 v[112:115], v16 offset:4096
    v_mfma_f32_16x16x32_bf16 v[100:103], a[124:127], v[168:171], v[100:103]
    s_waitcnt vmcnt(20)
    v_cmp_eq_u32 vcc, -1, v172
    v_mfma_f32_16x16x32_bf16 v[104:107], a[148:151], v[168:171], v[104:107]
    s_mov_b32 s61, 225280
    buffer_load_dwordx4 v[156:159], v16, s[36:39], s61 offen sc1
L_ff_rb1:
    s_cbranch_vccnz L_ff_rt2
    v_mfma_f32_16x16x32_bf16 v[92:95], a[152:155], v[172:175], v[92:95]
    ds_read_b128 v[128:131], v16 offset:36864
    ds_read_b128 v[52:55], v16 offset:53248
    v_mfma_f32_16x16x32_bf16 v[96:99], a[156:159], v[172:175], v[96:99]
    ds_read_b128 v[116:119], v16 offset:8192
    ds_read_b128 v[132:135], v16 offset:40960
    v_mfma_f32_16x16x32_bf16 v[100:103], a[176:179], v[172:175], v[100:103]
    s_waitcnt vmcnt(20)
    v_cmp_eq_u32 vcc, -1, v176
    v_mfma_f32_16x16x32_bf16 v[104:107], a[184:187], v[172:175], v[104:107]
    ds_read_b128 v[56:59], v16 offset:57344
    ds_read_b128 v[120:123], v16 offset:12288
L_ff_rb2:
    s_cbranch_vccnz L_ff_rt3
    v_mfma_f32_16x16x32_bf16 v[92:95], a[188:191], v[176:179], v[92:95]
    ds_read_b128 v[136:139], v16 offset:45056
    ds_read_b128 v[60:63], v16 offset:61440
    v_mfma_f32_16x16x32_bf16 v[96:99], a[208:211], v[176:179], v[96:99]
    ds_read_b128 a[204:207], v4 offset:5120
    v_mfma_f32_16x16x32_bf16 v[100:103], a[216:219], v[176:179], v[100:103]
    s_waitcnt vmcnt(19)
    v_cmp_eq_u32 vcc, -1, v196
    v_mfma_f32_16x16x32_bf16 v[104:107], a[220:223], v[176:179], v[104:107]
    ds_read_b128 a[16:19], v4 offset:8192
L_ff_rb3:
    s_cbranch_vccnz L_ff_rt4
    v_mfma_f32_16x16x32_bf16 v[92:95], a[0:3], v[196:199], v[92:95]
    ds_read_b128 a[20:23], v4 offset:11264
    s_waitcnt lgkmcnt(12)
    v_add_f32 v124, v124, v48
    v_add_f32 v125, v125, v49
    v_mfma_f32_16x16x32_bf16 v[96:99], a[12:15], v[196:199], v[96:99]
    ds_read_b128 a[244:247], v4 offset:14336
    v_add_f32 v126, v126, v50
    v_add_f32 v127, v127, v51
    v_mfma_f32_16x16x32_bf16 v[100:103], a[32:35], v[196:199], v[100:103]
    s_waitcnt vmcnt(18)
    v_cmp_eq_u32 vcc, -1, v200
    v_mfma_f32_16x16x32_bf16 v[104:107], a[252:255], v[196:199], v[104:107]
    ds_read_b128 a[80:83], v4 offset:17408
    v_add_f32 v108, v108, v124
    v_add_f32 v109, v109, v125
L_ff_rb4:
    s_cbranch_vccnz L_ff_rt5
    v_mfma_f32_16x16x32_bf16 v[92:95], a[248:251], v[200:203], v[92:95]
    ds_read_b128 a[84:87], v4 offset:20480
    v_add_f32 v110, v110, v126
    v_add_f32 v111, v111, v127
    v_mfma_f32_16x16x32_bf16 v[96:99], a[240:243], v[200:203], v[96:99]
    ds_read_b128 a[88:91], v4 offset:23552
    s_waitcnt lgkmcnt(13)
    v_add_f32 v128, v128, v52
    v_add_f32 v129, v129, v53
    v_mfma_f32_16x16x32_bf16 v[100:103], a[8:11], v[200:203], v[100:103]
    s_waitcnt vmcnt(17)
    v_cmp_eq_u32 vcc, -1, v204
    v_mfma_f32_16x16x32_bf16 v[104:107], a[36:39], v[200:203], v[104:107]
    ds_read_b128 a[92:95], v4 offset:26624
    v_add_f32 v130, v130, v54
    v_add_f32 v131, v131, v55
L_ff_rb5:
    s_cbranch_vccnz L_ff_rt6
    v_mfma_f32_16x16x32_bf16 v[92:95], a[236:239], v[204:207], v[92:95]
    ds_read_b128 a[116:119], v4 offset:29696
    v_add_f32 v112, v112, v128
    v_add_f32 v113, v113, v129
    v_mfma_f32_16x16x32_bf16 v[96:99], a[232:235], v[204:207], v[96:99]
    ds_read_b128 a[120:123], v4 offset:32768
    v_add_f32 v114, v114, v130
    v_add_f32 v115, v115, v131
    v_mfma_f32_16x16x32_bf16 v[100:103], a[228:231], v[204:207], v[100:103]
    s_waitcnt vmcnt(16)
    v_cmp_eq_u32 vcc, -1, v208
    v_mfma_f32_16x16x32_bf16 v[104:107], a[224:227], v[204:207], v[104:107]
    ds_read_b128 a[124:127], v4 offset:35840
    s_waitcnt lgkmcnt(14)
    v_add_f32 v132, v132, v56
    v_add_f32 v133, v133, v57
L_ff_rb6:
    s_cbranch_vccnz L_ff_rt7
    v_mfma_f32_16x16x32_bf16 v[92:95], a[40:43], v[208:211], v[92:95]
    ds_read_b128 a[148:151], v4 offset:38912
    v_add_f32 v134, v134, v58
    v_add_f32 v135, v135, v59
    v_mfma_f32_16x16x32_bf16 v[96:99], a[44:47], v[208:211], v[96:99]
    ds_read_b128 a[152:155], v4 offset:41984
    v_add_f32 v116, v116, v132
    v_add_f32 v117, v117, v133
    v_mfma_f32_16x16x32_bf16 v[100:103], a[64:67], v[208:211], v[100:103]
    s_waitcnt vmcnt(15)
    v_cmp_eq_u32 vcc, -1, v212
    v_mfma_f32_16x16x32_bf16 v[104:107], a[68:71], v[208:211], v[104:107]
    ds_read_b128 a[156:159], v4 offset:45056
    v_add_f32 v118, v118, v134
    v_add_f32 v119, v119, v135
L_ff_rb7:
    s_cbranch_vccnz L_ff_rt8
    v_mfma_f32_16x16x32_bf16 v[92:95], a[72:75], v[212:215], v[92:95]
    ds_read_b128 a[176:179], v4 offset:48128
    s_waitcnt lgkmcnt(14)
    v_add_f32 v136, v136, v60
    v_add_f32 v137, v137, v61
    v_mfma_f32_16x16x32_bf16 v[96:99], a[104:107], v[212:215], v[96:99]
    ds_read_b128 a[184:187], v7 offset:2048
    v_add_f32 v138, v138, v62
    v_add_f32 v139, v139, v63
    v_mfma_f32_16x16x32_bf16 v[100:103], a[108:111], v[212:215], v[100:103]
    s_waitcnt vmcnt(14)
    v_cmp_eq_u32 vcc, -1, v216
    v_mfma_f32_16x16x32_bf16 v[104:107], a[128:131], v[212:215], v[104:107]
    ds_read_b128 a[188:191], v7 offset:5120
    v_add_f32 v120, v120, v136
    v_add_f32 v121, v121, v137
L_ff_rb8:
    s_cbranch_vccnz L_ff_rt9
    v_mfma_f32_16x16x32_bf16 v[92:95], a[132:135], v[216:219], v[92:95]
    ds_read_b128 a[208:211], v7 offset:8192
    v_add_f32 v122, v122, v138
    v_add_f32 v123, v123, v139
    v_mfma_f32_16x16x32_bf16 v[96:99], a[168:171], v[216:219], v[96:99]
    ds_read_b128 a[216:219], v7 offset:11264
    v_mfma_f32_16x16x32_bf16 v[100:103], a[172:175], v[216:219], v[100:103]
    s_waitcnt vmcnt(13)
    v_cmp_eq_u32 vcc, -1, v220
    v_mfma_f32_16x16x32_bf16 v[104:107], a[192:195], v[216:219], v[104:107]
    ds_read_b128 a[220:223], v7 offset:14336
L_ff_rb9:
    s_cbranch_vccnz L_ff_rt10
    v_mfma_f32_16x16x32_bf16 v[92:95], v[180:183], v[220:223], v[92:95]
    ds_read_b128 a[0:3], v7 offset:17408
    v_mfma_f32_16x16x32_bf16 v[96:99], v[184:187], v[220:223], v[96:99]
    ds_read_b128 a[12:15], v7 offset:20480
    v_mfma_f32_16x16x32_bf16 v[100:103], v[188:191], v[220:223], v[100:103]
    s_waitcnt vmcnt(12)
    v_cmp_eq_u32 vcc, -1, v160
    v_mfma_f32_16x16x32_bf16 v[104:107], a[196:199], v[220:223], v[104:107]
    ds_read_b128 a[32:35], v7 offset:23552
L_ff_rb10:
    s_cbranch_vccnz L_ff_rt11
    v_mfma_f32_16x16x32_bf16 v[92:95], v[192:195], v[160:163], v[92:95]
    ds_read_b128 a[252:255], v7 offset:26624
    v_mfma_f32_16x16x32_bf16 v[96:99], a[24:27], v[160:163], v[96:99]
    ds_read_b128 a[248:251], v7 offset:29696
    v_mfma_f32_16x16x32_bf16 v[100:103], a[28:31], v[160:163], v[100:103]
    s_waitcnt vmcnt(11)
    v_cmp_eq_u32 vcc, -1, v252
    v_mfma_f32_16x16x32_bf16 v[104:107], a[48:51], v[160:163], v[104:107]
    ds_read_b128 a[240:243], v7 offset:32768
L_ff_rb11:
    s_cbranch_vccnz L_ff_rt12
    v_mfma_f32_16x16x32_bf16 v[92:95], a[76:79], v[252:255], v[92:95]
    ds_read_b128 a[8:11], v7 offset:35840
    v_mfma_f32_16x16x32_bf16 v[96:99], a[96:99], v[252:255], v[96:99]
    ds_read_b128 a[36:39], v7 offset:38912
    v_mfma_f32_16x16x32_bf16 v[100:103], a[100:103], v[252:255], v[100:103]
    s_waitcnt vmcnt(10)
    v_cmp_eq_u32 vcc, -1, v224
    v_mfma_f32_16x16x32_bf16 v[104:107], a[52:55], v[252:255], v[104:107]
    ds_read_b128 a[236:239], v7 offset:41984
L_ff_rb12:
    s_cbranch_vccnz L_ff_rt13
    v_mfma_f32_16x16x32_bf16 v[92:95], v[232:235], v[224:227], v[92:95]
    ds_read_b128 a[232:235], v7 offset:45056
    v_mfma_f32_16x16x32_bf16 v[96:99], a[56:59], v[224:227], v[96:99]
    ds_read_b128 a[228:231], v7 offset:48128
    v_mfma_f32_16x16x32_bf16 v[100:103], a[60:63], v[224:227], v[100:103]
    s_waitcnt vmcnt(9)
    v_cmp_eq_u32 vcc, -1, v228
    v_mfma_f32_16x16x32_bf16 v[104:107], a[112:115], v[224:227], v[104:107]
L_ff_rb13:
    s_cbranch_vccnz L_ff_rt14
    v_mfma_f32_16x16x32_bf16 v[92:95], a[144:147], v[228:231], v[92:95]
L_tf14:
    s_cbranch_execz L_tret
    v_mfma_f32_16x16x32_bf16 v[96:99], a[180:183], v[228:231], v[96:99]
    v_mfma_f32_16x16x32_bf16 v[100:103], a[212:215], v[228:231], v[100:103]
    s_waitcnt vmcnt(8)
    v_cmp_eq_u32 vcc, -1, v236
    v_mfma_f32_16x16x32_bf16 v[104:107], a[136:139], v[228:231], v[104:107]
L_ff_rb14:
    s_cbranch_vccnz L_ff_rt15
    v_mfma_f32_16x16x32_bf16 v[92:95], a[140:143], v[236:239], v[92:95]
    v_mfma_f32_16x16x32_bf16 v[96:99], a[160:163], v[236:239], v[96:99]
    v_mfma_f32_16x16x32_bf16 v[100:103], a[164:167], v[236:239], v[100:103]
    s_waitcnt vmcnt(7) lgkmcnt(14)
    v_cmp_eq_u32 vcc, -1, v240
    v_mfma_f32_16x16x32_bf16 v[104:107], a[4:7], v[236:239], v[104:107]
L_ff_rb15:
    s_cbranch_vccnz L_ff_rt16
    v_mfma_f32_16x16x32_bf16 v[92:95], a[200:203], v[240:243], v[92:95]
    v_mfma_f32_16x16x32_bf16 v[96:99], a[204:207], v[240:243], v[96:99]
    v_mfma_f32_16x16x32_bf16 v[100:103], a[16:19], v[240:243], v[100:103]
    s_waitcnt vmcnt(6)
    v_cmp_eq_u32 vcc, -1, v244
    v_mfma_f32_16x16x32_bf16 v[104:107], a[20:23], v[240:243], v[104:107]
L_ff_rb16:
    s_cbranch_vccnz L_ff_rt17
    v_mfma_f32_16x16x32_bf16 v[92:95], a[244:247], v[244:247], v[92:95]
    v_mfma_f32_16x16x32_bf16 v[96:99], a[80:83], v[244:247], v[96:99]
    v_mfma_f32_16x16x32_bf16 v[100:103], a[84:87], v[244:247], v[100:103]
    s_waitcnt vmcnt(5)
    v_cmp_eq_u32 vcc, -1, v248
    v_mfma_f32_16x16x32_bf16 v[104:107], a[88:91], v[244:247], v[104:107]
L_ff_rb17:
    s_cbranch_vccnz L_ff_rt18
    v_mfma_f32_16x16x32_bf16 v[92:95], a[92:95], v[248:251], v[92:95]
    v_mfma_f32_16x16x32_bf16 v[96:99], a[116:119], v[248:251], v[96:99]
    v_mfma_f32_16x16x32_bf16 v[100:103], a[120:123], v[248:251], v[100:103]
    s_waitcnt vmcnt(4)
    v_cmp_eq_u32 vcc, -1, v140
    v_mfma_f32_16x16x32_bf16 v[104:107], a[124:127], v[248:251], v[104:107]
L_ff_rb18:
    s_cbranch_vccnz L_ff_rt19
    v_mfma_f32_16x16x32_bf16 v[92:95], a[148:151], v[140:143], v[92:95]
    v_mfma_f32_16x16x32_bf16 v[96:99], a[152:155], v[140:143], v[96:99]
    v_mfma_f32_16x16x32_bf16 v[100:103], a[156:159], v[140:143], v[100:103]
    s_waitcnt vmcnt(3) lgkmcnt(12)
    v_cmp_eq_u32 vcc, -1, v144
    v_mfma_f32_16x16x32_bf16 v[104:107], a[176:179], v[140:143], v[104:107]
L_ff_rb19:
    s_cbranch_vccnz L_ff_rt20
    v_mfma_f32_16x16x32_bf16 v[92:95], a[184:187], v[144:147], v[92:95]
    v_mfma_f32_16x16x32_bf16 v[96:99], a[188:191], v[144:147], v[96:99]
    v_mfma_f32_16x16x32_bf16 v[100:103], a[208:211], v[144:147], v[100:103]
    s_waitcnt vmcnt(2) lgkmcnt(8)
    v_cmp_eq_u32 vcc, -1, v148
    v_mfma_f32_16x16x32_bf16 v[104:107], a[216:219], v[144:147], v[104:107]
L_ff_rb20:
    s_cbranch_vccnz L_ff_rt21
    v_mfma_f32_16x16x32_bf16 v[92:95], a[220:223], v[148:151], v[92:95]
    v_mfma_f32_16x16x32_bf16 v[96:99], a[0:3], v[148:151], v[96:99]
    v_mfma_f32_16x16x32_bf16 v[100:103], a[12:15], v[148:151], v[100:103]
    s_waitcnt vmcnt(1) lgkmcnt(4)
    v_cmp_eq_u32 vcc, -1, v152
    v_mfma_f32_16x16x32_bf16 v[104:107], a[32:35], v[148:151], v[104:107]
L_ff_rb21:
    s_cbranch_vccnz L_ff_rt22
    v_mfma_f32_16x16x32_bf16 v[92:95], a[252:255], v[152:155], v[92:95]
    v_mfma_f32_16x16x32_bf16 v[96:99], a[248:251], v[152:155], v[96:99]
    v_mfma_f32_16x16x32_bf16 v[100:103], a[240:243], v[152:155], v[100:103]
    s_waitcnt vmcnt(0) lgkmcnt(0)
    v_cmp_eq_u32 vcc, -1, v156
    v_mfma_f32_16x16x32_bf16 v[104:107], a[8:11], v[152:155], v[104:107]
L_ff_rb22:
    s_cbranch_vccnz L_ff_rt23
    v_mfma_f32_16x16x32_bf16 v[92:95], a[36:39], v[156:159], v[92:95]
    v_mfma_f32_16x16x32_bf16 v[96:99], a[236:239], v[156:159], v[96:99]
    v_mfma_f32_16x16x32_bf16 v[100:103], a[232:235], v[156:159], v[100:103]
    v_mfma_f32_16x16x32_bf16 v[104:107], a[228:231], v[156:159], v[104:107]
L_ff_rb23:
    s_cmp_lg_u32 s17, 0
    s_cbranch_scc1 L_ff_scan
L_ff_done:
    s_nop 2
    v_pk_add_f32 v[92:93], v[92:93], v[108:109]
    v_pk_add_f32 v[94:95], v[94:95], v[110:111]
    v_cvt_pk_bf16_f32 v84, v92, v93
    v_cvt_pk_bf16_f32 v85, v94, v95
    v_pk_add_f32 v[96:97], v[96:97], v[112:113]
    v_pk_add_f32 v[98:99], v[98:99], v[114:115]
    v_cvt_pk_bf16_f32 v86, v96, v97
    v_cvt_pk_bf16_f32 v87, v98, v99
    s_nop 0
    v_permlane16_swap_b32 v84, v86
    v_permlane16_swap_b32 v85, v87
    buffer_store_dwordx4 v[84:87], v76, s[24:27], 0 offen offset:0
    v_pk_add_f32 v[100:101], v[100:101], v[116:117]
    v_pk_add_f32 v[102:103], v[102:103], v[118:119]
    v_cvt_pk_bf16_f32 v88, v100, v101
    v_cvt_pk_bf16_f32 v89, v102, v103
    v_pk_add_f32 v[104:105], v[104:105], v[120:121]
    v_pk_add_f32 v[106:107], v[106:107], v[122:123]
    v_cvt_pk_bf16_f32 v90, v104, v105
    v_cvt_pk_bf16_f32 v91, v106, v107
    s_nop 0
    v_permlane16_swap_b32 v88, v90
    v_permlane16_swap_b32 v89, v91
    buffer_store_dwordx4 v[88:91], v76, s[24:27], 0 offen offset:64
    v_cmp_u_f32 vcc, v92, v92
    s_cbranch_vccnz L_ff_redo
L_ff_rback:
L_ff_fin:
L_ff_end:
    s_endpgm
L_ff_slow0:
    s_cmp_eq_u32 s58, 7
    s_cbranch_scc1 L_ff_back0
    buffer_load_dword v30, v29, s[32:35], 0 offen offset:0 sc1
    s_sub_u32 s62, s62, 1
    s_cbranch_scc1 L_ff_end
    s_waitcnt vmcnt(0)
    v_cmp_ne_u32 vcc, s0, v30
    s_cbranch_vccnz L_ff_slow0
    s_branch L_ff_back0
L_ff_scan:
    s_waitcnt vmcnt(0)
    s_bitcmp1_b32 s17, 0
    s_cbranch_scc1 L_ff_sb0
L_ff_sr0:
    s_bitcmp1_b32 s17, 1
    s_cbranch_scc1 L_ff_sb1
L_ff_sr1:
    s_bitcmp1_b32 s17, 2
    s_cbranch_scc1 L_ff_sb2
L_ff_sr2:
    s_bitcmp1_b32 s17, 3
    s_cbranch_scc1 L_ff_sb3
L_ff_sr3:
    s_bitcmp1_b32 s17, 4
    s_cbranch_scc1 L_ff_sb4
L_ff_sr4:
    s_bitcmp1_b32 s17, 5
    s_cbranch_scc1 L_ff_sb5
L_ff_sr5:
    s_bitcmp1_b32 s17, 6
    s_cbranch_scc1 L_ff_sb6
L_ff_sr6:
    s_bitcmp1_b32 s17, 7
    s_cbranch_scc1 L_ff_sb7
L_ff_sr7:
    s_bitcmp1_b32 s17, 8
    s_cbranch_scc1 L_ff_sb8
L_ff_sr8:
    s_bitcmp1_b32 s17, 9
    s_cbranch_scc1 L_ff_sb9
L_ff_sr9:
    s_bitcmp1_b32 s17, 10
    s_cbranch_scc1 L_ff_sb10
L_ff_sr10:
    s_bitcmp1_b32 s17, 11
    s_cbranch_scc1 L_ff_sb11
L_ff_sr11:
    s_bitcmp1_b32 s17, 12
    s_cbranch_scc1 L_ff_sb12
L_ff_sr12:
    s_bitcmp1_b32 s17, 13
    s_cbranch_scc1 L_ff_sb13
L_ff_sr13:
    s_bitcmp1_b32 s17, 14
    s_cbranch_scc1 L_ff_sb14
L_ff_sr14:
    s_bitcmp1_b32 s17, 15
    s_cbranch_scc1 L_ff_sb15
L_ff_sr15:
    s_bitcmp1_b32 s17, 16
    s_cbranch_scc1 L_ff_sb16
L_ff_sr16:
    s_bitcmp1_b32 s17, 17
    s_cbranch_scc1 L_ff_sb17
L_ff_sr17:
    s_bitcmp1_b32 s17, 18
    s_cbranch_scc1 L_ff_sb18
L_ff_sr18:
    s_bitcmp1_b32 s17, 19
    s_cbranch_scc1 L_ff_sb19
L_ff_sr19:
    s_bitcmp1_b32 s17, 20
    s_cbranch_scc1 L_ff_sb20
L_ff_sr20:
    s_bitcmp1_b32 s17, 21
    s_cbranch_scc1 L_ff_sb21
L_ff_sr21:
    s_bitcmp1_b32 s17, 22
    s_cbranch_scc1 L_ff_sb22
L_ff_sr22:
    s_bitcmp1_b32 s17, 23
    s_cbranch_scc1 L_ff_sb23
L_ff_sr23:
    s_cmp_eq_u32 s17, 0
    s_nop 7
    s_cbranch_scc1 L_ff_done
    s_sub_u32 s62, s62, 1
    s_cbranch_scc0 L_ff_scan
    s_mov_b32 s62, 0
    s_branch L_ff_redo
L_ff_rt0:
    s_bitset1_b32 s17, 0
    s_nop 7
    ds_read_b128 a[200:203], v4 offset:2048
    s_waitcnt lgkmcnt(2)
    s_barrier
    s_waitcnt vmcnt(20)
    v_cmp_eq_u32 vcc, -1, v168
    s_mov_b32 s61, 196608
    buffer_load_dwordx4 v[152:155], v16, s[36:39], s61 offen sc1
    s_nop 7
    s_branch L_ff_rb0
L_ff_sb0:
    v_cmp_eq_u32 vcc, -1, v164
    s_cbranch_vccnz L_ff_sl0
    s_nop 7
    ds_read_b128 v[32:35], v4 offset:0
    ds_read_b128 v[36:39], v4 offset:3072
    ds_read_b128 v[40:43], v4 offset:6144
    ds_read_b128 v[44:47], v4 offset:9216
    s_waitcnt lgkmcnt(0)
    v_mfma_f32_16x16x32_bf16 v[92:95], v[32:35], v[164:167], v[92:95]
    v_mfma_f32_16x16x32_bf16 v[96:99], v[36:39], v[164:167], v[96:99]
    v_mfma_f32_16x16x32_bf16 v[100:103], v[40:43], v[164:167], v[100:103]
    v_mfma_f32_16x16x32_bf16 v[104:107], v[44:47], v[164:167], v[104:107]
    s_bitset0_b32 s17, 0
    s_branch L_ff_sr0
L_ff_sl0:
    s_mov_b32 s63, 16384
L_tf15:
    s_cbranch_execz L_tret
    buffer_load_dwordx4 v[164:167], v16, s[36:39], s63 offen sc1
    s_branch L_ff_sr0
L_ff_rt1:
    s_bitset1_b32 s17, 1
    s_nop 7
    ds_read_b128 v[108:111], v16 offset:0
    ds_read_b128 v[124:127], v16 offset:32768
    ds_read_b128 v[48:51], v16 offset:49152
    ds_read_b128 v[112:115], v16 offset:4096
    s_waitcnt vmcnt(20)
    v_cmp_eq_u32 vcc, -1, v172
    s_mov_b32 s61, 225280
    buffer_load_dwordx4 v[156:159], v16, s[36:39], s61 offen sc1
    s_nop 7
    s_branch L_ff_rb1
L_ff_sb1:
    v_cmp_eq_u32 vcc, -1, v168
    s_cbranch_vccnz L_ff_sl1
    s_nop 7
    ds_read_b128 v[32:35], v4 offset:12288
    ds_read_b128 v[36:39], v4 offset:15360
    ds_read_b128 v[40:43], v4 offset:18432
    ds_read_b128 v[44:47], v4 offset:21504
    s_waitcnt lgkmcnt(0)
    v_mfma_f32_16x16x32_bf16 v[92:95], v[32:35], v[168:171], v[92:95]
    v_mfma_f32_16x16x32_bf16 v[96:99], v[36:39], v[168:171], v[96:99]
    v_mfma_f32_16x16x32_bf16 v[100:103], v[40:43], v[168:171], v[100:103]
    v_mfma_f32_16x16x32_bf16 v[104:107], v[44:47], v[168:171], v[104:107]
    s_bitset0_b32 s17, 1
    s_branch L_ff_sr1
L_ff_sl1:
    s_mov_b32 s63, 45056
    buffer_load_dwordx4 v[168:171], v16, s[36:39], s63 offen sc1
    s_branch L_ff_sr1
L_ff_rt2:
    s_bitset1_b32 s17, 2
    s_mov_b32 s63, 73728
    buffer_load_dwordx4 v[172:175], v16, s[36:39], s63 offen sc1
    s_nop 7
    ds_read_b128 v[128:131], v16 offset:36864
    ds_read_b128 v[52:55], v16 offset:53248
    ds_read_b128 v[116:119], v16 offset:8192
    ds_read_b128 v[132:135], v16 offset:40960
    s_waitcnt vmcnt(20)
    v_cmp_eq_u32 vcc, -1, v176
    ds_read_b128 v[56:59], v16 offset:57344
    ds_read_b128 v[120:123], v16 offset:12288
    s_nop 7
    s_branch L_ff_rb2
L_ff_sb2:
    v_cmp_eq_u32 vcc, -1, v172
    s_cbranch_vccnz L_ff_sl2
    s_nop 7
    ds_read_b128 v[32:35], v4 offset:24576
    ds_read_b128 v[36:39], v4 offset:27648
    ds_read_b128 v[40:43], v4 offset:30720
    ds_read_b128 v[44:47], v4 offset:33792
    s_waitcnt lgkmcnt(0)
    v_mfma_f32_16x16x32_bf16 v[92:95], v[32:35], v[172:175], v[92:95]
    v_mfma_f32_16x16x32_bf16 v[96:99], v[36:39], v[172:175], v[96:99]
    v_mfma_f32_16x16x32_bf16 v[100:103], v[40:43], v[172:175], v[100:103]
    v_mfma_f32_16x16x32_bf16 v[104:107], v[44:47], v[172:175], v[104:107]
    s_bitset0_b32 s17, 2
    s_branch L_ff_sr2
L_ff_sl2:
    s_mov_b32 s63, 73728
    buffer_load_dwordx4 v[172:175], v16, s[36:39], s63 offen sc1
    s_branch L_ff_sr2
L_ff_rt3:
    s_bitset1_b32 s17, 3
    s_mov_b32 s63, 102400
    buffer_load_dwordx4 v[176:179], v16, s[36:39], s63 offen sc1
    s_nop 7
    ds_read_b128 v[136:139], v16 offset:45056
    ds_read_b128 v[60:63], v16 offset:61440
    ds_read_b128 a[204:207], v4 offset:5120
    s_waitcnt vmcnt(19)
    v_cmp_eq_u32 vcc, -1, v196
    ds_read_b128 a[16:19], v4 offset:8192
    s_nop 7
    s_branch L_ff_rb3
L_ff_sb3:
    v_cmp_eq_u32 vcc, -1, v176
    s_cbranch_vccnz L_ff_sl3
    s_nop 7
    ds_read_b128 v[32:35], v4 offset:36864
    ds_read_b128 v[36:39], v4 offset:39936
    ds_read_b128 v[40:43], v4 offset:43008
    ds_read_b128 v[44:47], v4 offset:46080
    s_waitcnt lgkmcnt(0)
    v_mfma_f32_16x16x32_bf16 v[92:95], v[32:35], v[176:179], v[92:95]
    v_mfma_f32_16x16x32_bf16 v[96:99], v[36:39], v[176:179], v[96:99]
    v_mfma_f32_16x16x32_bf16 v[100:103], v[40:43], v[176:179], v[100:103]
    v_mfma_f32_16x16x32_bf16 v[104:107], v[44:47], v[176:179], v[104:107]
    s_bitset0_b32 s17, 3
    s_branch L_ff_sr3
L_ff_sl3:
    s_mov_b32 s63, 102400
    buffer_load_dwordx4 v[176:179], v16, s[36:39], s63 offen sc1
    s_branch L_ff_sr3
L_ff_rt4:
    s_bitset1_b32 s17, 4
    s_mov_b32 s63, 131072
    buffer_load_dwordx4 v[196:199], v16, s[36:39], s63 offen sc1
    s_nop 7
    ds_read_b128 a[20:23], v4 offset:11264
    s_waitcnt lgkmcnt(12)
    v_add_f32 v124, v124, v48
    v_add_f32 v125, v125, v49
    ds_read_b128 a[244:247], v4 offset:14336
    v_add_f32 v126, v126, v50
    v_add_f32 v127, v127, v51
    s_waitcnt vmcnt(18)
    v_cmp_eq_u32 vcc, -1, v200
    ds_read_b128 a[80:83], v4 offset:17408
    v_add_f32 v108, v108, v124
    v_add_f32 v109, v109, v125
    s_nop 7
    s_branch L_ff_rb4
L_ff_sb4:
    v_cmp_eq_u32 vcc, -1, v196
    s_cbranch_vccnz L_ff_sl4
    s_nop 7
    ds_read_b128 v[32:35], v7 offset:0
    ds_read_b128 v[36:39], v7 offset:3072
    ds_read_b128 v[40:43], v7 offset:6144
    ds_read_b128 v[44:47], v7 offset:9216
    s_waitcnt lgkmcnt(0)
    v_mfma_f32_16x16x32_bf16 v[92:95], v[32:35], v[196:199], v[92:95]
    v_mfma_f32_16x16x32_bf16 v[96:99], v[36:39], v[196:199], v[96:99]
    v_mfma_f32_16x16x32_bf16 v[100:103], v[40:43], v[196:199], v[100:103]
    v_mfma_f32_16x16x32_bf16 v[104:107], v[44:47], v[196:199], v[104:107]
    s_bitset0_b32 s17, 4
    s_branch L_ff_sr4
L_ff_sl4:
    s_mov_b32 s63, 131072
    buffer_load_dwordx4 v[196:199], v16, s[36:39], s63 offen sc1
    s_branch L_ff_sr4
L_ff_rt5:
    s_bitset1_b32 s17, 5
    s_mov_b32 s63, 159744
    buffer_load_dwordx4 v[200:203], v16, s[36:39], s63 offen sc1
    s_nop 7
    ds_read_b128 a[84:87], v4 offset:20480
    v_add_f32 v110, v110, v126
    v_add_f32 v111, v111, v127
    ds_read_b128 a[88:91], v4 offset:23552
    s_waitcnt lgkmcnt(13)
    v_add_f32 v128, v128, v52
    v_add_f32 v129, v129, v53
L_tf16:
    s_cbranch_execz L_tret
    s_waitcnt vmcnt(17)
    v_cmp_eq_u32 vcc, -1, v204
    ds_read_b128 a[92:95], v4 offset:26624
    v_add_f32 v130, v130, v54
    v_add_f32 v131, v131, v55
    s_nop 7
    s_branch L_ff_rb5
L_ff_sb5:
    v_cmp_eq_u32 vcc, -1, v200
    s_cbranch_vccnz L_ff_sl5
    s_nop 7
    ds_read_b128 v[32:35], v7 offset:12288
    ds_read_b128 v[36:39], v7 offset:15360
    ds_read_b128 v[40:43], v7 offset:18432
    ds_read_b128 v[44:47], v7 offset:21504
    s_waitcnt lgkmcnt(0)
    v_mfma_f32_16x16x32_bf16 v[92:95], v[32:35], v[200:203], v[92:95]
    v_mfma_f32_16x16x32_bf16 v[96:99], v[36:39], v[200:203], v[96:99]
    v_mfma_f32_16x16x32_bf16 v[100:103], v[40:43], v[200:203], v[100:103]
    v_mfma_f32_16x16x32_bf16 v[104:107], v[44:47], v[200:203], v[104:107]
    s_bitset0_b32 s17, 5
    s_branch L_ff_sr5
L_ff_sl5:
    s_mov_b32 s63, 159744
    buffer_load_dwordx4 v[200:203], v16, s[36:39], s63 offen sc1
    s_branch L_ff_sr5
L_ff_rt6:
    s_bitset1_b32 s17, 6
    s_mov_b32 s63, 188416
    buffer_load_dwordx4 v[204:207], v16, s[36:39], s63 offen sc1
    s_nop 7
    ds_read_b128 a[116:119], v4 offset:29696
    v_add_f32 v112, v112, v128
    v_add_f32 v113, v113, v129
    ds_read_b128 a[120:123], v4 offset:32768
    v_add_f32 v114, v114, v130
    v_add_f32 v115, v115, v131
    s_waitcnt vmcnt(16)
    v_cmp_eq_u32 vcc, -1, v208
    ds_read_b128 a[124:127], v4 offset:35840
    s_waitcnt lgkmcnt(14)
    v_add_f32 v132, v132, v56
    v_add_f32 v133, v133, v57
    s_nop 7
    s_branch L_ff_rb6
L_ff_sb6:
    v_cmp_eq_u32 vcc, -1, v204
    s_cbranch_vccnz L_ff_sl6
    s_nop 7
    ds_read_b128 v[32:35], v7 offset:24576
    ds_read_b128 v[36:39], v7 offset:27648
    ds_read_b128 v[40:43], v7 offset:30720
    ds_read_b128 v[44:47], v7 offset:33792
    s_waitcnt lgkmcnt(0)
    v_mfma_f32_16x16x32_bf16 v[92:95], v[32:35], v[204:207], v[92:95]
    v_mfma_f32_16x16x32_bf16 v[96:99], v[36:39], v[204:207], v[96:99]
    v_mfma_f32_16x16x32_bf16 v[100:103], v[40:43], v[204:207], v[100:103]
    v_mfma_f32_16x16x32_bf16 v[104:107], v[44:47], v[204:207], v[104:107]
    s_bitset0_b32 s17, 6
    s_branch L_ff_sr6
L_ff_sl6:
    s_mov_b32 s63, 188416
    buffer_load_dwordx4 v[204:207], v16, s[36:39], s63 offen sc1
    s_branch L_ff_sr6
L_ff_rt7:
    s_bitset1_b32 s17, 7
    s_mov_b32 s63, 217088
    buffer_load_dwordx4 v[208:211], v16, s[36:39], s63 offen sc1
    s_nop 7
    ds_read_b128 a[148:151], v4 offset:38912
    v_add_f32 v134, v134, v58
    v_add_f32 v135, v135, v59
    ds_read_b128 a[152:155], v4 offset:41984
    v_add_f32 v116, v116, v132
    v_add_f32 v117, v117, v133
    s_waitcnt vmcnt(15)
    v_cmp_eq_u32 vcc, -1, v212
    ds_read_b128 a[156:159], v4 offset:45056
    v_add_f32 v118, v118, v134
    v_add_f32 v119, v119, v135
    s_nop 7
    s_branch L_ff_rb7
L_ff_sb7:
    v_cmp_eq_u32 vcc, -1, v208
    s_cbranch_vccnz L_ff_sl7
    s_nop 7
    ds_read_b128 v[32:35], v7 offset:36864
    ds_read_b128 v[36:39], v7 offset:39936
    ds_read_b128 v[40:43], v7 offset:43008
    ds_read_b128 v[44:47], v7 offset:46080
    s_waitcnt lgkmcnt(0)
    v_mfma_f32_16x16x32_bf16 v[92:95], v[32:35], v[208:211], v[92:95]
    v_mfma_f32_16x16x32_bf16 v[96:99], v[36:39], v[208:211], v[96:99]
    v_mfma_f32_16x16x32_bf16 v[100:103], v[40:43], v[208:211], v[100:103]
    v_mfma_f32_16x16x32_bf16 v[104:107], v[44:47], v[208:211], v[104:107]
    s_bitset0_b32 s17, 7
    s_branch L_ff_sr7
L_ff_sl7:
    s_mov_b32 s63, 217088
    buffer_load_dwordx4 v[208:211], v16, s[36:39], s63 offen sc1
    s_branch L_ff_sr7
L_ff_rt8:
    s_bitset1_b32 s17, 8
    s_mov_b32 s63, 20480
    buffer_load_dwordx4 v[212:215], v16, s[36:39], s63 offen sc1
    s_nop 7
    ds_read_b128 a[176:179], v4 offset:48128
    s_waitcnt lgkmcnt(14)
    v_add_f32 v136, v136, v60
    v_add_f32 v137, v137, v61
    ds_read_b128 a[184:187], v7 offset:2048
    v_add_f32 v138, v138, v62
    v_add_f32 v139, v139, v63
    s_waitcnt vmcnt(14)
    v_cmp_eq_u32 vcc, -1, v216
    ds_read_b128 a[188:191], v7 offset:5120
    v_add_f32 v120, v120, v136
    v_add_f32 v121, v121, v137
    s_nop 7
    s_branch L_ff_rb8
L_ff_sb8:
    v_cmp_eq_u32 vcc, -1, v212
    s_cbranch_vccnz L_ff_sl8
    v_mfma_f32_16x16x32_bf16 v[92:95], a[72:75], v[212:215], v[92:95]
    v_mfma_f32_16x16x32_bf16 v[96:99], a[104:107], v[212:215], v[96:99]
    v_mfma_f32_16x16x32_bf16 v[100:103], a[108:111], v[212:215], v[100:103]
    v_mfma_f32_16x16x32_bf16 v[104:107], a[128:131], v[212:215], v[104:107]
    s_bitset0_b32 s17, 8
    s_branch L_ff_sr8
L_ff_sl8:
    s_mov_b32 s63, 20480
    buffer_load_dwordx4 v[212:215], v16, s[36:39], s63 offen sc1
    s_branch L_ff_sr8
L_ff_rt9:
    s_bitset1_b32 s17, 9
    s_mov_b32 s63, 49152
    buffer_load_dwordx4 v[216:219], v16, s[36:39], s63 offen sc1
    s_nop 7
    ds_read_b128 a[208:211], v7 offset:8192
    v_add_f32 v122, v122, v138
    v_add_f32 v123, v123, v139
    ds_read_b128 a[216:219], v7 offset:11264
    s_waitcnt vmcnt(13)
    v_cmp_eq_u32 vcc, -1, v220
    ds_read_b128 a[220:223], v7 offset:14336
    s_nop 7
    s_branch L_ff_rb9
L_ff_sb9:
    v_cmp_eq_u32 vcc, -1, v216
    s_cbranch_vccnz L_ff_sl9
    v_mfma_f32_16x16x32_bf16 v[92:95], a[132:135], v[216:219], v[92:95]
    v_mfma_f32_16x16x32_bf16 v[96:99], a[168:171], v[216:219], v[96:99]
    v_mfma_f32_16x16x32_bf16 v[100:103], a[172:175], v[216:219], v[100:103]
    v_mfma_f32_16x16x32_bf16 v[104:107], a[192:195], v[216:219], v[104:107]
    s_bitset0_b32 s17, 9
    s_branch L_ff_sr9
L_ff_sl9:
    s_mov_b32 s63, 49152
    buffer_load_dwordx4 v[216:219], v16, s[36:39], s63 offen sc1
    s_branch L_ff_sr9
L_ff_rt10:
    s_bitset1_b32 s17, 10
    s_mov_b32 s63, 77824
    buffer_load_dwordx4 v[220:223], v16, s[36:39], s63 offen sc1
    s_nop 7
    ds_read_b128 a[0:3], v7 offset:17408
    ds_read_b128 a[12:15], v7 offset:20480
    s_waitcnt vmcnt(12)
    v_cmp_eq_u32 vcc, -1, v160
    ds_read_b128 a[32:35], v7 offset:23552
    s_nop 7
    s_branch L_ff_rb10
L_ff_sb10:
    v_cmp_eq_u32 vcc, -1, v220
    s_cbranch_vccnz L_ff_sl10
    v_mfma_f32_16x16x32_bf16 v[92:95], v[180:183], v[220:223], v[92:95]
    v_mfma_f32_16x16x32_bf16 v[96:99], v[184:187], v[220:223], v[96:99]
    v_mfma_f32_16x16x32_bf16 v[100:103], v[188:191], v[220:223], v[100:103]
    v_mfma_f32_16x16x32_bf16 v[104:107], a[196:199], v[220:223], v[104:107]
    s_bitset0_b32 s17, 10
    s_branch L_ff_sr10
L_ff_sl10:
    s_mov_b32 s63, 77824
    buffer_load_dwordx4 v[220:223], v16, s[36:39], s63 offen sc1
    s_branch L_ff_sr10
L_ff_rt11:
    s_bitset1_b32 s17, 11
    s_mov_b32 s63, 106496
    buffer_load_dwordx4 v[160:163], v16, s[36:39], s63 offen sc1
    s_nop 7
    ds_read_b128 a[252:255], v7 offset:26624
    ds_read_b128 a[248:251], v7 offset:29696
    s_waitcnt vmcnt(11)
    v_cmp_eq_u32 vcc, -1, v252
    ds_read_b128 a[240:243], v7 offset:32768
    s_nop 7
    s_branch L_ff_rb11
L_ff_sb11:
    v_cmp_eq_u32 vcc, -1, v160
    s_cbranch_vccnz L_ff_sl11
    v_mfma_f32_16x16x32_bf16 v[92:95], v[192:195], v[160:163], v[92:95]
    v_mfma_f32_16x16x32_bf16 v[96:99], a[24:27], v[160:163], v[96:99]
    v_mfma_f32_16x16x32_bf16 v[100:103], a[28:31], v[160:163], v[100:103]
    v_mfma_f32_16x16x32_bf16 v[104:107], a[48:51], v[160:163], v[104:107]
    s_bitset0_b32 s17, 11
    s_branch L_ff_sr11
L_ff_sl11:
    s_mov_b32 s63, 106496
L_tf17:
    s_cbranch_execz L_tret
    buffer_load_dwordx4 v[160:163], v16, s[36:39], s63 offen sc1
    s_branch L_ff_sr11
L_ff_rt12:
    s_bitset1_b32 s17, 12
    s_mov_b32 s63, 135168
    buffer_load_dwordx4 v[252:255], v16, s[36:39], s63 offen sc1
    s_nop 7
    ds_read_b128 a[8:11], v7 offset:35840
    ds_read_b128 a[36:39], v7 offset:38912
    s_waitcnt vmcnt(10)
    v_cmp_eq_u32 vcc, -1, v224
    ds_read_b128 a[236:239], v7 offset:41984
    s_nop 7
    s_branch L_ff_rb12
L_ff_sb12:
    v_cmp_eq_u32 vcc, -1, v252
    s_cbranch_vccnz L_ff_sl12
    v_mfma_f32_16x16x32_bf16 v[92:95], a[76:79], v[252:255], v[92:95]
    v_mfma_f32_16x16x32_bf16 v[96:99], a[96:99], v[252:255], v[96:99]
    v_mfma_f32_16x16x32_bf16 v[100:103], a[100:103], v[252:255], v[100:103]
    v_mfma_f32_16x16x32_bf16 v[104:107], a[52:55], v[252:255], v[104:107]
    s_bitset0_b32 s17, 12
    s_branch L_ff_sr12
L_ff_sl12:
    s_mov_b32 s63, 135168
    buffer_load_dwordx4 v[252:255], v16, s[36:39], s63 offen sc1
    s_branch L_ff_sr12
L_ff_rt13:
    s_bitset1_b32 s17, 13
    s_mov_b32 s63, 163840
    buffer_load_dwordx4 v[224:227], v16, s[36:39], s63 offen sc1
    s_nop 7
    ds_read_b128 a[232:235], v7 offset:45056
    ds_read_b128 a[228:231], v7 offset:48128
    s_waitcnt vmcnt(9)
    v_cmp_eq_u32 vcc, -1, v228
    s_nop 7
    s_branch L_ff_rb13
L_ff_sb13:
    v_cmp_eq_u32 vcc, -1, v224
    s_cbranch_vccnz L_ff_sl13
    v_mfma_f32_16x16x32_bf16 v[92:95], v[232:235], v[224:227], v[92:95]
    v_mfma_f32_16x16x32_bf16 v[96:99], a[56:59], v[224:227], v[96:99]
    v_mfma_f32_16x16x32_bf16 v[100:103], a[60:63], v[224:227], v[100:103]
    v_mfma_f32_16x16x32_bf16 v[104:107], a[112:115], v[224:227], v[104:107]
    s_bitset0_b32 s17, 13
    s_branch L_ff_sr13
L_ff_sl13:
    s_mov_b32 s63, 163840
    buffer_load_dwordx4 v[224:227], v16, s[36:39], s63 offen sc1
    s_branch L_ff_sr13
L_ff_rt14:
    s_bitset1_b32 s17, 14
    s_mov_b32 s63, 192512
    buffer_load_dwordx4 v[228:231], v16, s[36:39], s63 offen sc1
    s_nop 7
    s_waitcnt vmcnt(8)
    v_cmp_eq_u32 vcc, -1, v236
    s_nop 7
    s_branch L_ff_rb14
L_ff_sb14:
    v_cmp_eq_u32 vcc, -1, v228
    s_cbranch_vccnz L_ff_sl14
    v_mfma_f32_16x16x32_bf16 v[92:95], a[144:147], v[228:231], v[92:95]
    v_mfma_f32_16x16x32_bf16 v[96:99], a[180:183], v[228:231], v[96:99]
    v_mfma_f32_16x16x32_bf16 v[100:103], a[212:215], v[228:231], v[100:103]
    v_mfma_f32_16x16x32_bf16 v[104:107], a[136:139], v[228:231], v[104:107]
    s_bitset0_b32 s17, 14
    s_branch L_ff_sr14
L_ff_sl14:
    s_mov_b32 s63, 192512
    buffer_load_dwordx4 v[228:231], v16, s[36:39], s63 offen sc1
    s_branch L_ff_sr14
L_ff_rt15:
    s_bitset1_b32 s17, 15
    s_mov_b32 s63, 221184
    buffer_load_dwordx4 v[236:239], v16, s[36:39], s63 offen sc1
    s_nop 7
    s_waitcnt vmcnt(7) lgkmcnt(14)
    v_cmp_eq_u32 vcc, -1, v240
    s_nop 7
    s_branch L_ff_rb15
L_ff_sb15:
    v_cmp_eq_u32 vcc, -1, v236
    s_cbranch_vccnz L_ff_sl15
    v_mfma_f32_16x16x32_bf16 v[92:95], a[140:143], v[236:239], v[92:95]
    v_mfma_f32_16x16x32_bf16 v[96:99], a[160:163], v[236:239], v[96:99]
    v_mfma_f32_16x16x32_bf16 v[100:103], a[164:167], v[236:239], v[100:103]
    v_mfma_f32_16x16x32_bf16 v[104:107], a[4:7], v[236:239], v[104:107]
    s_bitset0_b32 s17, 15
    s_branch L_ff_sr15
L_ff_sl15:
    s_mov_b32 s63, 221184
    buffer_load_dwordx4 v[236:239], v16, s[36:39], s63 offen sc1
    s_branch L_ff_sr15
L_ff_rt16:
    s_bitset1_b32 s17, 16
    s_mov_b32 s63, 24576
    buffer_load_dwordx4 v[240:243], v16, s[36:39], s63 offen sc1
    s_nop 7
    s_waitcnt vmcnt(6)
    v_cmp_eq_u32 vcc, -1, v244
    s_nop 7
    s_branch L_ff_rb16
L_ff_sb16:
    v_cmp_eq_u32 vcc, -1, v240
    s_cbranch_vccnz L_ff_sl16
    v_mfma_f32_16x16x32_bf16 v[92:95], a[200:203], v[240:243], v[92:95]
    v_mfma_f32_16x16x32_bf16 v[96:99], a[204:207], v[240:243], v[96:99]
    v_mfma_f32_16x16x32_bf16 v[100:103], a[16:19], v[240:243], v[100:103]
    v_mfma_f32_16x16x32_bf16 v[104:107], a[20:23], v[240:243], v[104:107]
    s_bitset0_b32 s17, 16
    s_branch L_ff_sr16
L_ff_sl16:
    s_mov_b32 s63, 24576
    buffer_load_dwordx4 v[240:243], v16, s[36:39], s63 offen sc1
    s_branch L_ff_sr16
L_ff_rt17:
    s_bitset1_b32 s17, 17
    s_mov_b32 s63, 53248
    buffer_load_dwordx4 v[244:247], v16, s[36:39], s63 offen sc1
    s_nop 7
    s_waitcnt vmcnt(5)
    v_cmp_eq_u32 vcc, -1, v248
    s_nop 7
    s_branch L_ff_rb17
L_ff_sb17:
    v_cmp_eq_u32 vcc, -1, v244
    s_cbranch_vccnz L_ff_sl17
    v_mfma_f32_16x16x32_bf16 v[92:95], a[244:247], v[244:247], v[92:95]
    v_mfma_f32_16x16x32_bf16 v[96:99], a[80:83], v[244:247], v[96:99]
    v_mfma_f32_16x16x32_bf16 v[100:103], a[84:87], v[244:247], v[100:103]
    v_mfma_f32_16x16x32_bf16 v[104:107], a[88:91], v[244:247], v[104:107]
    s_bitset0_b32 s17, 17
    s_branch L_ff_sr17
L_ff_sl17:
    s_mov_b32 s63, 53248
    buffer_load_dwordx4 v[244:247], v16, s[36:39], s63 offen sc1
    s_branch L_ff_sr17
L_ff_rt18:
    s_bitset1_b32 s17, 18
    s_mov_b32 s63, 81920
    buffer_load_dwordx4 v[248:251], v16, s[36:39], s63 offen sc1
    s_nop 7
    s_waitcnt vmcnt(4)
    v_cmp_eq_u32 vcc, -1, v140
    s_nop 7
    s_branch L_ff_rb18
L_ff_sb18:
    v_cmp_eq_u32 vcc, -1, v248
    s_cbranch_vccnz L_ff_sl18
    v_mfma_f32_16x16x32_bf16 v[92:95], a[92:95], v[248:251], v[92:95]
    v_mfma_f32_16x16x32_bf16 v[96:99], a[116:119], v[248:251], v[96:99]
    v_mfma_f32_16x16x32_bf16 v[100:103], a[120:123], v[248:251], v[100:103]
    v_mfma_f32_16x16x32_bf16 v[104:107], a[124:127], v[248:251], v[104:107]
    s_bitset0_b32 s17, 18
    s_branch L_ff_sr18
L_ff_sl18:
    s_mov_b32 s63, 81920
    buffer_load_dwordx4 v[248:251], v16, s[36:39], s63 offen sc1
    s_branch L_ff_sr18
L_ff_rt19:
    s_bitset1_b32 s17, 19
    s_mov_b32 s63, 110592
    buffer_load_dwordx4 v[140:143], v16, s[36:39], s63 offen sc1
    s_nop 7
    s_waitcnt vmcnt(3) lgkmcnt(12)
    v_cmp_eq_u32 vcc, -1, v144
    s_nop 7
    s_branch L_ff_rb19
L_ff_sb19:
    v_cmp_eq_u32 vcc, -1, v140
    s_cbranch_vccnz L_ff_sl19
    v_mfma_f32_16x16x32_bf16 v[92:95], a[148:151], v[140:143], v[92:95]
    v_mfma_f32_16x16x32_bf16 v[96:99], a[152:155], v[140:143], v[96:99]
    v_mfma_f32_16x16x32_bf16 v[100:103], a[156:159], v[140:143], v[100:103]
    v_mfma_f32_16x16x32_bf16 v[104:107], a[176:179], v[140:143], v[104:107]
    s_bitset0_b32 s17, 19
    s_branch L_ff_sr19
L_ff_sl19:
    s_mov_b32 s63, 110592
    buffer_load_dwordx4 v[140:143], v16, s[36:39], s63 offen sc1
    s_branch L_ff_sr19
L_ff_rt20:
    s_bitset1_b32 s17, 20
    s_mov_b32 s63, 139264
    buffer_load_dwordx4 v[144:147], v16, s[36:39], s63 offen sc1
    s_nop 7
    s_waitcnt vmcnt(2) lgkmcnt(8)
    v_cmp_eq_u32 vcc, -1, v148
    s_nop 7
    s_branch L_ff_rb20
L_ff_sb20:
    v_cmp_eq_u32 vcc, -1, v144
    s_cbranch_vccnz L_ff_sl20
    v_mfma_f32_16x16x32_bf16 v[92:95], a[184:187], v[144:147], v[92:95]
    v_mfma_f32_16x16x32_bf16 v[96:99], a[188:191], v[144:147], v[96:99]
    v_mfma_f32_16x16x32_bf16 v[100:103], a[208:211], v[144:147], v[100:103]
    v_mfma_f32_16x16x32_bf16 v[104:107], a[216:219], v[144:147], v[104:107]
    s_bitset0_b32 s17, 20
    s_branch L_ff_sr20
L_ff_sl20:
    s_mov_b32 s63, 139264
    buffer_load_dwordx4 v[144:147], v16, s[36:39], s63 offen sc1
    s_branch L_ff_sr20
L_ff_rt21:
    s_bitset1_b32 s17, 21
    s_mov_b32 s63, 167936
    buffer_load_dwordx4 v[148:151], v16, s[36:39], s63 offen sc1
    s_nop 7
    s_waitcnt vmcnt(1) lgkmcnt(4)
    v_cmp_eq_u32 vcc, -1, v152
    s_nop 7
    s_branch L_ff_rb21
L_ff_sb21:
    v_cmp_eq_u32 vcc, -1, v148
    s_cbranch_vccnz L_ff_sl21
    v_mfma_f32_16x16x32_bf16 v[92:95], a[220:223], v[148:151], v[92:95]
L_tf18:
    s_cbranch_execz L_tret
    v_mfma_f32_16x16x32_bf16 v[96:99], a[0:3], v[148:151], v[96:99]
    v_mfma_f32_16x16x32_bf16 v[100:103], a[12:15], v[148:151], v[100:103]
    v_mfma_f32_16x16x32_bf16 v[104:107], a[32:35], v[148:151], v[104:107]
    s_bitset0_b32 s17, 21
    s_branch L_ff_sr21
L_ff_sl21:
    s_mov_b32 s63, 167936
    buffer_load_dwordx4 v[148:151], v16, s[36:39], s63 offen sc1
    s_branch L_ff_sr21
L_ff_rt22:
    s_bitset1_b32 s17, 22
    s_mov_b32 s63, 196608
    buffer_load_dwordx4 v[152:155], v16, s[36:39], s63 offen sc1
    s_nop 7
    s_waitcnt vmcnt(0) lgkmcnt(0)
    v_cmp_eq_u32 vcc, -1, v156
    s_nop 7
    s_branch L_ff_rb22
L_ff_sb22:
    v_cmp_eq_u32 vcc, -1, v152
    s_cbranch_vccnz L_ff_sl22
    v_mfma_f32_16x16x32_bf16 v[92:95], a[252:255], v[152:155], v[92:95]
    v_mfma_f32_16x16x32_bf16 v[96:99], a[248:251], v[152:155], v[96:99]
    v_mfma_f32_16x16x32_bf16 v[100:103], a[240:243], v[152:155], v[100:103]
    v_mfma_f32_16x16x32_bf16 v[104:107], a[8:11], v[152:155], v[104:107]
    s_bitset0_b32 s17, 22
    s_branch L_ff_sr22
L_ff_sl22:
    s_mov_b32 s63, 196608
    buffer_load_dwordx4 v[152:155], v16, s[36:39], s63 offen sc1
    s_branch L_ff_sr22
L_ff_rt23:
    s_bitset1_b32 s17, 23
    s_mov_b32 s63, 225280
    buffer_load_dwordx4 v[156:159], v16, s[36:39], s63 offen sc1
    s_nop 7
    s_nop 7
    s_branch L_ff_rb23
L_ff_sb23:
    v_cmp_eq_u32 vcc, -1, v156
    s_cbranch_vccnz L_ff_sl23
    v_mfma_f32_16x16x32_bf16 v[92:95], a[36:39], v[156:159], v[92:95]
    v_mfma_f32_16x16x32_bf16 v[96:99], a[236:239], v[156:159], v[96:99]
    v_mfma_f32_16x16x32_bf16 v[100:103], a[232:235], v[156:159], v[100:103]
    v_mfma_f32_16x16x32_bf16 v[104:107], a[228:231], v[156:159], v[104:107]
    s_bitset0_b32 s17, 23
    s_branch L_ff_sr23
L_ff_sl23:
    s_mov_b32 s63, 225280
    buffer_load_dwordx4 v[156:159], v16, s[36:39], s63 offen sc1
    s_branch L_ff_sr23
L_ff_redo:
    s_waitcnt vmcnt(0) lgkmcnt(0)
    s_nop 7
    v_lshlrev_b32 v92, 16, v24
    v_and_b32 v93, 0xffff0000, v24
    v_lshlrev_b32 v94, 16, v25
    v_and_b32 v95, 0xffff0000, v25
    v_lshlrev_b32 v96, 16, v26
    v_and_b32 v97, 0xffff0000, v26
    v_lshlrev_b32 v98, 16, v27
    v_and_b32 v99, 0xffff0000, v27
    v_lshlrev_b32 v100, 16, v8
    v_and_b32 v101, 0xffff0000, v8
    v_lshlrev_b32 v102, 16, v9
    v_and_b32 v103, 0xffff0000, v9
    v_lshlrev_b32 v104, 16, v10
    v_and_b32 v105, 0xffff0000, v10
    v_lshlrev_b32 v106, 16, v11
    v_and_b32 v107, 0xffff0000, v11
    s_mul_i32 s4, s19, 401408
    s_sub_u32 s28, s28, s4
    s_subb_u32 s29, s29, 0
    s_mov_b32 s30, 1433600
    s_mov_b32 s61, 0
    s_mov_b32 s4, 0
    s_mov_b32 s63, 0
L_ff_rl:
    s_add_u32 s5, s4, 7168
    s_add_u32 s6, s4, 14336
    s_add_u32 s7, s4, 21504
    buffer_load_dwordx4 v[140:143], v4, s[28:31], s4 offen
    buffer_load_dwordx4 v[144:147], v4, s[28:31], s5 offen
    buffer_load_dwordx4 v[148:151], v4, s[28:31], s6 offen
    buffer_load_dwordx4 v[152:155], v4, s[28:31], s7 offen
L_ff_rr:
    buffer_load_dwordx4 v[156:159], v16, s[36:39], s61 offen sc1
    s_waitcnt vmcnt(0)
    v_max_u32 v30, v156, v157
    v_max3_u32 v30, v30, v158, v159
    v_cmp_eq_u32 vcc, -1, v30
    s_cbranch_vccz L_ff_rok
    s_sub_u32 s62, s62, 1
    s_cbranch_scc0 L_ff_rr
    s_mov_b32 s62, 0
L_ff_rok:
    v_mfma_f32_16x16x32_bf16 v[92:95], v[140:143], v[156:159], v[92:95]
    v_mfma_f32_16x16x32_bf16 v[96:99], v[144:147], v[156:159], v[96:99]
    v_mfma_f32_16x16x32_bf16 v[100:103], v[148:151], v[156:159], v[100:103]
    v_mfma_f32_16x16x32_bf16 v[104:107], v[152:155], v[156:159], v[104:107]
    s_add_u32 s61, s61, 4096
    s_add_u32 s4, s4, 1024
    s_add_u32 s63, s63, 1
    s_cmp_eq_u32 s63, 7
    s_cselect_b32 s63, 0, s63
    s_cselect_b32 s5, 193536, 0
    s_add_u32 s4, s4, s5
    s_nop 7
    s_nop 7
    s_cmp_lt_u32 s61, 229376
    s_cbranch_scc1 L_ff_rl
    v_cvt_pk_bf16_f32 v84, v92, v93
    v_cvt_pk_bf16_f32 v85, v94, v95
    v_cvt_pk_bf16_f32 v86, v96, v97
    v_cvt_pk_bf16_f32 v87, v98, v99
    s_nop 0
    v_permlane16_swap_b32 v84, v86
    v_permlane16_swap_b32 v85, v87
    buffer_store_dwordx4 v[84:87], v76, s[24:27], 0 offen offset:0
    v_cvt_pk_bf16_f32 v88, v100, v101
    v_cvt_pk_bf16_f32 v89, v102, v103
    v_cvt_pk_bf16_f32 v90, v104, v105
    v_cvt_pk_bf16_f32 v91, v106, v107
    s_nop 0
    v_permlane16_swap_b32 v88, v90
    v_permlane16_swap_b32 v89, v91
    buffer_store_dwordx4 v[88:91], v76, s[24:27], 0 offen offset:64
    s_branch L_ff_rback
L_fu_last:
L_pc_end:
    s_endpgm
L_pc_sl:
    buffer_load_dwordx4 v[80:83], v132, s[64:67], s45 offen offset:0 sc1
    buffer_load_dwordx4 v[84:87], v132, s[64:67], s45 offen offset:1024 sc1
    buffer_load_dwordx4 v[88:91], v132, s[64:67], s45 offen offset:2048 sc1
    buffer_load_dwordx4 v[92:95], v132, s[64:67], s45 offen offset:3072 sc1
    s_sub_u32 s100, s100, 1
    s_cbranch_scc1 L_pc_end
    s_waitcnt vmcnt(0)
    v_and_b32 v6, v81, v83
    v_or_b32 v7, v81, v83
    v_bitop3_b32 v6, v85, v87, v6 bitop3:0x80
    v_or3_b32 v7, v85, v87, v7
    v_bitop3_b32 v6, v89, v91, v6 bitop3:0x80
    v_or3_b32 v7, v89, v91, v7
    v_bitop3_b32 v6, v93, v95, v6 bitop3:0x80
    v_or3_b32 v7, v93, v95, v7
    v_xor_b32 v6, s3, v6
    v_xor_b32 v7, s3, v7
    v_or_b32 v6, v6, v7
    v_cmp_ne_u32 vcc, 0, v6
    s_cbranch_vccnz L_pc_sl
    s_branch L_pc_sb
L_fu_w1:
    buffer_load_dword v10, v15, s[32:35], 0 offen sc1
    s_sub_u32 s62, s62, 1
    s_cbranch_scc1 L_pc_end
    s_waitcnt vmcnt(0)
    v_cmp_ne_u32 vcc, s0, v10
    s_cbranch_vccz L_fu_w1b
    s_sleep 10
    s_branch L_fu_w1
L_fu_w2:
    buffer_load_dword v10, v15, s[32:35], 0 offen sc1
    s_sub_u32 s100, s100, 1
    s_cbranch_scc1 L_pc_end
    s_waitcnt vmcnt(0)
    v_cmp_ne_u32 vcc, s3, v10
    s_cbranch_vccz L_fu_w2b
    s_sleep 10
    s_branch L_fu_w2
.p2align 12
L_pc_spare:
    s_mov_b64 exec, -1
    s_branch L_pc_sp2
L_tdis:
    s_cmp_eq_u32 s52, 0
    s_cbranch_scc1 L_ts0
    s_cmp_eq_u32 s52, 1
    s_cbranch_scc1 L_ts1
    s_cmp_eq_u32 s52, 2
    s_cbranch_scc1 L_ts2
    s_cmp_eq_u32 s52, 3
    s_cbranch_scc1 L_tp0
    s_cmp_eq_u32 s52, 4
    s_cbranch_scc1 L_tp1
    s_cmp_eq_u32 s52, 5
    s_cbranch_scc1 L_tp2
    s_cmp_eq_u32 s52, 6
    s_cbranch_scc1 L_tp3
    s_cmp_eq_u32 s52, 7
    s_cbranch_scc1 L_tf0
    s_cmp_eq_u32 s52, 8
    s_cbranch_scc1 L_tf1
    s_cmp_eq_u32 s52, 9
    s_cbranch_scc1 L_tf2
    s_cmp_eq_u32 s52, 10
    s_cbranch_scc1 L_tf3
    s_cmp_eq_u32 s52, 11
    s_cbranch_scc1 L_tf4
    s_cmp_eq_u32 s52, 12
    s_cbranch_scc1 L_tf5
    s_cmp_eq_u32 s52, 13
    s_cbranch_scc1 L_tf6
    s_cmp_eq_u32 s52, 14
    s_cbranch_scc1 L_tf7
    s_cmp_eq_u32 s52, 15
    s_cbranch_scc1 L_tf8
    s_cmp_eq_u32 s52, 16
    s_cbranch_scc1 L_tf9
    s_cmp_eq_u32 s52, 17
    s_cbranch_scc1 L_tf10
    s_cmp_eq_u32 s52, 18
    s_cbranch_scc1 L_tf11
    s_cmp_eq_u32 s52, 19
    s_cbranch_scc1 L_tf12
    s_cmp_eq_u32 s52, 20
    s_cbranch_scc1 L_tf13
    s_cmp_eq_u32 s52, 21
    s_cbranch_scc1 L_tf14
    s_cmp_eq_u32 s52, 22
    s_cbranch_scc1 L_tf15
    s_cmp_eq_u32 s52, 23
    s_cbranch_scc1 L_tf16
    s_cmp_eq_u32 s52, 24
    s_cbranch_scc1 L_tf17
    s_cmp_eq_u32 s52, 25
    s_cbranch_scc1 L_tf18
    s_cmp_eq_u32 s52, 26
    s_cbranch_scc1 L_tret
    s_cmp_eq_u32 s52, 27
    s_cbranch_scc1 L_tret
    s_cmp_eq_u32 s52, 28
    s_cbranch_scc1 L_tret
    s_cmp_eq_u32 s52, 29
    s_cbranch_scc1 L_tret
    s_cmp_eq_u32 s52, 30
    s_cbranch_scc1 L_tret
    s_cmp_eq_u32 s52, 31
    s_cbranch_scc1 L_tret
L_tret:
    s_add_u32 s52, s52, s55
L_tchk:
    s_cmp_lt_u32 s52, s39
    s_cbranch_scc1 L_tdis
    s_cmp_eq_u32 s54, 1
    s_cbranch_scc1 L_tret1
    s_cmp_eq_u32 s54, 2
    s_cbranch_scc1 L_tret2
    s_branch L_tret3
L_pc_sp2:
    s_load_dwordx4 s[8:11], s[0:1], 56
    s_sub_u32 s77, s2, 224
    s_lshl_b32 s14, s80, 5
    s_add_u32 s14, s14, s81
    s_lshl_b32 s38, s14, 2
    s_add_u32 s38, s38, s16
    s_mul_i32 s38, s38, 1792
    v_lshl_add_u32 v176, v1, 4, s38
    v_cmp_gt_u32 vcc, 56, v1
    v_mov_b32 v177, 0x80000000
    s_nop 0
    v_cndmask_b32 v176, v177, v176, vcc
    v_sub_u32 v177, 63, v1
    s_lshr_b32 s38, s14, 6
    s_lshl_b32 s38, s38, 2
    s_add_u32 s38, s38, s16
    s_lshl_b32 s38, s38, 6
    s_and_b32 s14, s14, 63
    s_add_u32 s14, s14, s38
    s_lshl_b32 s14, s14, 4
    v_lshl_add_u32 v177, v177, 24, s14
    s_mov_b32 s66, 0x1c0000
    s_mov_b32 s67, 0x00020000
    v_and_b32 v3, 15, v1
    v_lshrrev_b32 v4, 4, v1
    v_lshlrev_b32 v9, 24, v1
    s_lshl_b32 s15, s77, 7
    s_cmp_lt_u32 s77, 28
    s_cselect_b32 s58, 1602176, 0
    s_cselect_b32 s46, 114688, 0
    s_cselect_b32 s70, 512, 0
    s_cselect_b32 s15, s15, 0
    s_mov_b32 s62, s58
    s_mov_b32 s47, 0x00020000
    s_mov_b32 s59, 0x00020000
    s_mov_b32 s63, 0x00020000
    s_mov_b32 s71, 0x00020000
    v_lshrrev_b32 v233, 3, v1
    v_and_b32 v234, 7, v1
    v_mul_u32_u24 v232, 3584, v233
    v_lshl_add_u32 v232, v234, 4, v232
    s_mul_i32 s78, s16, 7
    s_waitcnt lgkmcnt(0)
    s_add_u32 s56, s8, s15
    s_addc_u32 s57, s9, 0
    s_add_u32 s60, s10, s15
    s_addc_u32 s61, s11, 0
    s_sleep 1
    buffer_load_dwordx4 v[156:159], v176, s[64:67], 0 offen
    buffer_load_dwordx4 v[160:163], v176, s[64:67], 0 offen offset:896
    s_add_u32 s14, s78, 0
    s_and_b32 s15, s14, 1
    s_lshl_b32 s14, s14, 1
    s_sub_u32 s14, s14, s15
    s_mul_i32 s14, s14, 28672
    s_add_u32 s15, s14, 57344
    buffer_load_dwordx4 v[16:19], v232, s[56:59], s14 offen
    buffer_load_dwordx4 v[20:23], v232, s[60:63], s14 offen
    buffer_load_dwordx4 v[24:27], v232, s[56:59], s15 offen
    buffer_load_dwordx4 v[28:31], v232, s[60:63], s15 offen
    s_add_u32 s14, s78, 1
    s_and_b32 s15, s14, 1
    s_lshl_b32 s14, s14, 1
    s_sub_u32 s14, s14, s15
    s_mul_i32 s14, s14, 28672
    s_add_u32 s15, s14, 57344
    buffer_load_dwordx4 v[32:35], v232, s[56:59], s14 offen
    buffer_load_dwordx4 v[36:39], v232, s[60:63], s14 offen
    buffer_load_dwordx4 v[40:43], v232, s[56:59], s15 offen
    buffer_load_dwordx4 v[44:47], v232, s[60:63], s15 offen
    buffer_load_dword v14, off, s[32:35], 0 sc1
    s_add_u32 s14, s78, 2
    s_and_b32 s15, s14, 1
    s_lshl_b32 s14, s14, 1
    s_sub_u32 s14, s14, s15
    s_mul_i32 s14, s14, 28672
    s_add_u32 s15, s14, 57344
    buffer_load_dwordx4 v[48:51], v232, s[56:59], s14 offen
    buffer_load_dwordx4 v[52:55], v232, s[60:63], s14 offen
    buffer_load_dwordx4 v[56:59], v232, s[56:59], s15 offen
    buffer_load_dwordx4 v[60:63], v232, s[60:63], s15 offen
    s_and_b32 s15, s77, 24
    s_lshr_b32 s15, s15, 1
    s_add_u32 s52, s15, s16
    s_add_u32 s52, s52, 3
    s_mov_b32 s39, 26
    s_mov_b32 s55, 32
    s_mov_b32 s54, 2
    s_mov_b64 exec, 0
    s_branch L_tchk
L_tret2:
    s_mov_b64 exec, -1
    s_add_u32 s14, s78, 3
    s_and_b32 s15, s14, 1
    s_lshl_b32 s14, s14, 1
    s_sub_u32 s14, s14, s15
    s_mul_i32 s14, s14, 28672
    s_add_u32 s15, s14, 57344
    buffer_load_dwordx4 v[64:67], v232, s[56:59], s14 offen
    buffer_load_dwordx4 v[68:71], v232, s[60:63], s14 offen
    buffer_load_dwordx4 v[72:75], v232, s[56:59], s15 offen
    buffer_load_dwordx4 v[76:79], v232, s[60:63], s15 offen
    s_add_u32 s14, s78, 4
    s_and_b32 s15, s14, 1
    s_lshl_b32 s14, s14, 1
    s_sub_u32 s14, s14, s15
    s_mul_i32 s14, s14, 28672
L_ts0:
    s_cbranch_execz L_pc_spare
    s_add_u32 s15, s14, 57344
    buffer_load_dwordx4 v[80:83], v232, s[56:59], s14 offen
    buffer_load_dwordx4 v[84:87], v232, s[60:63], s14 offen
    buffer_load_dwordx4 v[88:91], v232, s[56:59], s15 offen
    buffer_load_dwordx4 v[92:95], v232, s[60:63], s15 offen
    s_add_u32 s14, s78, 5
    s_and_b32 s15, s14, 1
    s_lshl_b32 s14, s14, 1
    s_sub_u32 s14, s14, s15
    s_mul_i32 s14, s14, 28672
    s_add_u32 s15, s14, 57344
    buffer_load_dwordx4 v[96:99], v232, s[56:59], s14 offen
    buffer_load_dwordx4 v[100:103], v232, s[60:63], s14 offen
    buffer_load_dwordx4 v[104:107], v232, s[56:59], s15 offen
    buffer_load_dwordx4 v[108:111], v232, s[60:63], s15 offen
    s_add_u32 s14, s78, 6
    s_and_b32 s15, s14, 1
    s_lshl_b32 s14, s14, 1
    s_sub_u32 s14, s14, s15
    s_mul_i32 s14, s14, 28672
    s_add_u32 s15, s14, 57344
    buffer_load_dwordx4 v[112:115], v232, s[56:59], s14 offen
    buffer_load_dwordx4 v[116:119], v232, s[60:63], s14 offen
    buffer_load_dwordx4 v[120:123], v232, s[56:59], s15 offen
    buffer_load_dwordx4 v[124:127], v232, s[60:63], s15 offen
    s_mul_i32 s14, s77, 114688
    s_add_u32 s14, s14, 0x1000000
    s_add_u32 s44, s12, s14
    s_addc_u32 s45, s13, 0
    s_lshl_b32 s14, s77, 9
    s_add_u32 s14, s14, 0x1380000
    s_add_u32 s68, s12, s14
    s_addc_u32 s69, s13, 0
    s_mul_i32 s76, s16, 16384
    v_xor_b32 v234, v4, v1
    v_lshl_add_u32 v233, v234, 4, s76
    v_bfe_u32 v234, v1, 2, 3
    v_lshrrev_b32 v235, 1, v234
    v_lshrrev_b32 v236, 5, v1
    v_xor_b32 v235, v235, v236
    v_lshlrev_b32 v234, 7, v234
    v_lshl_add_u32 v234, v235, 4, v234
    v_bfe_u32 v235, v1, 1, 1
    v_lshl_add_u32 v234, v235, 3, v234
    v_xor_b32 v235, 32, v234
    v_and_b32 v237, 1, v1
    v_mul_u32_u24 v237, 1088, v237
    v_add3_u32 v234, v234, v237, s76
    v_add3_u32 v235, v235, v237, s76
    v_lshrrev_b32 v15, 1, v3
    v_sub_u32 v15, v15, v236
    v_mul_u32_u24 v236, 14336, v236
    v_and_b32 v237, 31, v1
    v_lshl_add_u32 v236, v237, 4, v236
    s_lshl_b32 s14, s78, 9
    v_add_u32 v236, s14, v236
    s_lshl_b32 s14, s16, 10
    s_add_u32 s14, s14, 65536
    v_lshl_add_u32 v237, v1, 4, s14
    s_mov_b32 s41, 28672
    s_mov_b32 s42, 57344
    s_mov_b32 s43, 86016
    s_lshl_b32 s14, s16, 2
    s_add_u32 s15, s14, 65536
    v_lshl_add_u32 v238, v1, 4, s15
    v_lshlrev_b32 v239, 5, v3
    v_lshl_add_u32 v239, v4, 4, v239
    v_and_b32 v6, 1, v1
    v_lshl_add_u32 v239, v6, 20, v239
    v_add_u32 v239, s14, v239
    v_mov_b32 v6, 0x3f803f80
    v_cmp_eq_u32 vcc, 0, v15
    s_nop 1
    v_cndmask_b32 v212, 0, v6, vcc
    v_cndmask_b32 v213, 0, v6, vcc
    v_cndmask_b32 v214, 0, v6, vcc
    v_cndmask_b32 v215, 0, v6, vcc
    v_cmp_eq_u32 vcc, 2, v15
    s_nop 1
    v_cndmask_b32 v216, 0, v6, vcc
    v_cndmask_b32 v217, 0, v6, vcc
    v_cndmask_b32 v218, 0, v6, vcc
    v_cndmask_b32 v219, 0, v6, vcc
    v_cmp_eq_u32 vcc, 4, v15
    s_nop 1
    v_cndmask_b32 v220, 0, v6, vcc
    v_cndmask_b32 v221, 0, v6, vcc
    v_cndmask_b32 v222, 0, v6, vcc
    v_cndmask_b32 v223, 0, v6, vcc
    v_cmp_eq_u32 vcc, 6, v15
    s_nop 1
    v_cndmask_b32 v224, 0, v6, vcc
    v_cndmask_b32 v225, 0, v6, vcc
    v_cndmask_b32 v226, 0, v6, vcc
    v_cndmask_b32 v227, 0, v6, vcc
    s_waitcnt vmcnt(29)
    s_mov_b32 s64, s12
    s_mov_b32 s65, s13
    s_mov_b32 s66, 0x1000000
    s_mov_b32 s67, 0x00020000
    s_mov_b32 s15, 0x3f803f80
    v_dot2_f32_bf16 v164, v156, s15, 0
    v_dot2_f32_bf16 v165, v156, v156, 0
    v_dot2_f32_bf16 v166, v160, s15, 0
    v_dot2_f32_bf16 v167, v160, v160, 0
    v_dot2_f32_bf16 v164, v157, s15, v164
    v_dot2_f32_bf16 v165, v157, v157, v165
    v_dot2_f32_bf16 v166, v161, s15, v166
    v_dot2_f32_bf16 v167, v161, v161, v167
    v_dot2_f32_bf16 v164, v158, s15, v164
    v_dot2_f32_bf16 v165, v158, v158, v165
    v_dot2_f32_bf16 v166, v162, s15, v166
    v_dot2_f32_bf16 v167, v162, v162, v167
    v_dot2_f32_bf16 v164, v159, s15, v164
    v_dot2_f32_bf16 v165, v159, v159, v165
    v_dot2_f32_bf16 v166, v163, s15, v166
    v_dot2_f32_bf16 v167, v163, v163, v167
    v_add_f32_dpp v164, v164, v164 quad_perm:[1,0,3,2] row_mask:0xf bank_mask:0xf
    v_add_f32_dpp v165, v165, v165 quad_perm:[1,0,3,2] row_mask:0xf bank_mask:0xf
    v_add_f32_dpp v166, v166, v166 quad_perm:[1,0,3,2] row_mask:0xf bank_mask:0xf
    v_add_f32_dpp v167, v167, v167 quad_perm:[1,0,3,2] row_mask:0xf bank_mask:0xf
    v_add_f32_dpp v164, v164, v164 quad_perm:[2,3,0,1] row_mask:0xf bank_mask:0xf
    v_add_f32_dpp v165, v165, v165 quad_perm:[2,3,0,1] row_mask:0xf bank_mask:0xf
    v_add_f32_dpp v166, v166, v166 quad_perm:[2,3,0,1] row_mask:0xf bank_mask:0xf
    v_add_f32_dpp v167, v167, v167 quad_perm:[2,3,0,1] row_mask:0xf bank_mask:0xf
    v_add_f32_dpp v164, v164, v164 row_half_mirror row_mask:0xf bank_mask:0xf
    v_add_f32_dpp v165, v165, v165 row_half_mirror row_mask:0xf bank_mask:0xf
    v_add_f32_dpp v166, v166, v166 row_half_mirror row_mask:0xf bank_mask:0xf
    v_add_f32_dpp v167, v167, v167 row_half_mirror row_mask:0xf bank_mask:0xf
    v_add_f32_dpp v164, v164, v164 row_mirror row_mask:0xf bank_mask:0xf
    v_add_f32_dpp v165, v165, v165 row_mirror row_mask:0xf bank_mask:0xf
    v_add_f32_dpp v166, v166, v166 row_mirror row_mask:0xf bank_mask:0xf
    v_add_f32_dpp v167, v167, v167 row_mirror row_mask:0xf bank_mask:0xf
    v_add_f32_dpp v164, v164, v164 row_bcast:15 row_mask:0xa bank_mask:0xf
    v_add_f32_dpp v165, v165, v165 row_bcast:15 row_mask:0xa bank_mask:0xf
    v_add_f32_dpp v166, v166, v166 row_bcast:15 row_mask:0xa bank_mask:0xf
    v_add_f32_dpp v167, v167, v167 row_bcast:15 row_mask:0xa bank_mask:0xf
    v_add_f32_dpp v164, v164, v164 row_bcast:31 row_mask:0xc bank_mask:0xf
    v_add_f32_dpp v165, v165, v165 row_bcast:31 row_mask:0xc bank_mask:0xf
    v_add_f32_dpp v166, v166, v166 row_bcast:31 row_mask:0xc bank_mask:0xf
    v_add_f32_dpp v167, v167, v167 row_bcast:31 row_mask:0xc bank_mask:0xf
    v_mul_f32 v164, 0x3b124925, v164
    v_mul_f32 v165, 0x3b124925, v165
    v_fma_f32 v165, -v164, v164, v165
    v_max_f32 v165, 0, v165
    v_cvt_pk_bf16_f32 v168, v165, v165
    v_lshlrev_b32 v168, 16, v168
    v_add_f32 v168, 0x3727c5ac, v168
    v_cvt_pk_bf16_f32 v168, v168, v168
    v_lshlrev_b32 v168, 16, v168
    v_sqrt_f32 v168, v168
    s_nop 0
    v_cvt_pk_bf16_f32 v172, v164, v168
    v_mul_f32 v166, 0x3b124925, v166
    v_mul_f32 v167, 0x3b124925, v167
    v_fma_f32 v167, -v166, v166, v167
    v_max_f32 v167, 0, v167
    v_cvt_pk_bf16_f32 v170, v167, v167
    v_lshlrev_b32 v170, 16, v170
    v_add_f32 v170, 0x3727c5ac, v170
    v_cvt_pk_bf16_f32 v170, v170, v170
    v_lshlrev_b32 v170, 16, v170
    v_sqrt_f32 v170, v170
    s_nop 0
    v_cvt_pk_bf16_f32 v174, v166, v170
    s_waitcnt vmcnt(20)
L_pc_ns:
    v_readfirstlane_b32 s3, v14
    s_cmp_lg_u32 s3, 0
    s_cbranch_scc1 L_pc_gs
    buffer_load_dword v14, off, s[32:35], 0 sc1
    s_sub_u32 s100, s100, 1
L_ts1:
    s_cbranch_execz L_pc_spare
    s_cbranch_scc1 L_pc_end
    s_waitcnt vmcnt(0)
    s_branch L_pc_ns
L_pc_gs:
    s_add_u32 s32, s12, 0x13c0000
    s_addc_u32 s33, s13, 0
    s_mov_b32 s34, 0x40000
    s_mov_b32 s35, 0x00020000
    v_mov_b32 v173, s3
    v_mov_b32 v175, s3
    s_mov_b32 s15, 0x708000
    buffer_store_dwordx4 v[172:175], v177, s[64:67], s15 offen sc1
    s_waitcnt vmcnt(28)
    v_swap_b32 v17, v20
    v_swap_b32 v19, v22
    ds_write_b128 v233, v[16:19] offset:0
    ds_write_b128 v233, v[20:23] offset:1088
    s_waitcnt vmcnt(26)
    v_swap_b32 v25, v28
    v_swap_b32 v27, v30
    ds_write_b128 v233, v[24:27] offset:2304
    ds_write_b128 v233, v[28:31] offset:3392
    ds_read_b64_tr_b16 v[180:181], v234 offset:0
    ds_read_b64_tr_b16 v[182:183], v234 offset:2304
    ds_read_b64_tr_b16 v[184:185], v235 offset:0
    ds_read_b64_tr_b16 v[186:187], v235 offset:2304
    ds_read_b64_tr_b16 v[188:189], v234 offset:64
    ds_read_b64_tr_b16 v[190:191], v234 offset:2368
    ds_read_b64_tr_b16 v[192:193], v235 offset:64
    ds_read_b64_tr_b16 v[194:195], v235 offset:2368
    s_waitcnt vmcnt(24)
    v_swap_b32 v33, v36
    v_swap_b32 v35, v38
    ds_write_b128 v233, v[32:35] offset:4608
    ds_write_b128 v233, v[36:39] offset:5696
    s_waitcnt vmcnt(22)
    v_swap_b32 v41, v44
    v_swap_b32 v43, v46
    ds_write_b128 v233, v[40:43] offset:6912
    ds_write_b128 v233, v[44:47] offset:8000
    ds_read_b64_tr_b16 v[196:197], v234 offset:4608
    ds_read_b64_tr_b16 v[198:199], v234 offset:6912
    ds_read_b64_tr_b16 v[200:201], v235 offset:4608
    ds_read_b64_tr_b16 v[202:203], v235 offset:6912
    ds_read_b64_tr_b16 v[204:205], v234 offset:4672
    ds_read_b64_tr_b16 v[206:207], v234 offset:6976
    ds_read_b64_tr_b16 v[208:209], v235 offset:4672
    ds_read_b64_tr_b16 v[210:211], v235 offset:6976
    s_waitcnt lgkmcnt(14)
    v_mfma_f32_16x16x32_bf16 v[228:231], v[180:183], v[212:215], 0
    v_mfma_f32_16x16x32_bf16 v[228:231], v[184:187], v[216:219], v[228:231]
    v_mfma_f32_16x16x32_bf16 v[228:231], v[188:191], v[220:223], v[228:231]
    s_waitcnt lgkmcnt(12)
    v_mfma_f32_16x16x32_bf16 v[228:231], v[192:195], v[224:227], v[228:231]
    s_waitcnt vmcnt(19)
    v_swap_b32 v49, v52
    v_swap_b32 v51, v54
    ds_write_b128 v233, v[48:51] offset:0
    ds_write_b128 v233, v[52:55] offset:1088
    s_waitcnt vmcnt(17)
    v_swap_b32 v57, v60
    v_swap_b32 v59, v62
    ds_write_b128 v233, v[56:59] offset:2304
    ds_write_b128 v233, v[60:63] offset:3392
    ds_read_b64_tr_b16 v[180:181], v234 offset:0
    ds_read_b64_tr_b16 v[182:183], v234 offset:2304
    ds_read_b64_tr_b16 v[184:185], v235 offset:0
    ds_read_b64_tr_b16 v[186:187], v235 offset:2304
    ds_read_b64_tr_b16 v[188:189], v234 offset:64
    ds_read_b64_tr_b16 v[190:191], v234 offset:2368
    ds_read_b64_tr_b16 v[192:193], v235 offset:64
    ds_read_b64_tr_b16 v[194:195], v235 offset:2368
    s_waitcnt lgkmcnt(14)
    v_mfma_f32_16x16x32_bf16 v[228:231], v[196:199], v[212:215], v[228:231]
    v_mfma_f32_16x16x32_bf16 v[228:231], v[200:203], v[216:219], v[228:231]
    v_mfma_f32_16x16x32_bf16 v[228:231], v[204:207], v[220:223], v[228:231]
    s_waitcnt lgkmcnt(12)
    v_mfma_f32_16x16x32_bf16 v[228:231], v[208:211], v[224:227], v[228:231]
    s_waitcnt vmcnt(15)
    v_swap_b32 v65, v68
    v_swap_b32 v67, v70
    ds_write_b128 v233, v[64:67] offset:4608
    ds_write_b128 v233, v[68:71] offset:5696
    s_waitcnt vmcnt(13)
    v_swap_b32 v73, v76
    v_swap_b32 v75, v78
    ds_write_b128 v233, v[72:75] offset:6912
    ds_write_b128 v233, v[76:79] offset:8000
    ds_read_b64_tr_b16 v[196:197], v234 offset:4608
    ds_read_b64_tr_b16 v[198:199], v234 offset:6912
    ds_read_b64_tr_b16 v[200:201], v235 offset:4608
    ds_read_b64_tr_b16 v[202:203], v235 offset:6912
    ds_read_b64_tr_b16 v[204:205], v234 offset:4672
    ds_read_b64_tr_b16 v[206:207], v234 offset:6976
    ds_read_b64_tr_b16 v[208:209], v235 offset:4672
    ds_read_b64_tr_b16 v[210:211], v235 offset:6976
    s_waitcnt lgkmcnt(14)
    v_mfma_f32_16x16x32_bf16 v[228:231], v[180:183], v[212:215], v[228:231]
    v_mfma_f32_16x16x32_bf16 v[228:231], v[184:187], v[216:219], v[228:231]
    v_mfma_f32_16x16x32_bf16 v[228:231], v[188:191], v[220:223], v[228:231]
    s_waitcnt lgkmcnt(12)
    v_mfma_f32_16x16x32_bf16 v[228:231], v[192:195], v[224:227], v[228:231]
    s_waitcnt vmcnt(11)
    v_swap_b32 v81, v84
    v_swap_b32 v83, v86
    ds_write_b128 v233, v[80:83] offset:0
    ds_write_b128 v233, v[84:87] offset:1088
    s_waitcnt vmcnt(9)
    v_swap_b32 v89, v92
    v_swap_b32 v91, v94
    ds_write_b128 v233, v[88:91] offset:2304
    ds_write_b128 v233, v[92:95] offset:3392
    ds_read_b64_tr_b16 v[180:181], v234 offset:0
    ds_read_b64_tr_b16 v[182:183], v234 offset:2304
    ds_read_b64_tr_b16 v[184:185], v235 offset:0
    ds_read_b64_tr_b16 v[186:187], v235 offset:2304
    ds_read_b64_tr_b16 v[188:189], v234 offset:64
    ds_read_b64_tr_b16 v[190:191], v234 offset:2368
    ds_read_b64_tr_b16 v[192:193], v235 offset:64
    ds_read_b64_tr_b16 v[194:195], v235 offset:2368
    s_waitcnt lgkmcnt(14)
    v_mfma_f32_16x16x32_bf16 v[228:231], v[196:199], v[212:215], v[228:231]
    v_mfma_f32_16x16x32_bf16 v[228:231], v[200:203], v[216:219], v[228:231]
    v_mfma_f32_16x16x32_bf16 v[228:231], v[204:207], v[220:223], v[228:231]
    s_waitcnt lgkmcnt(12)
    v_mfma_f32_16x16x32_bf16 v[228:231], v[208:211], v[224:227], v[228:231]
    s_waitcnt vmcnt(7)
    v_swap_b32 v97, v100
    v_swap_b32 v99, v102
    ds_write_b128 v233, v[96:99] offset:4608
    ds_write_b128 v233, v[100:103] offset:5696
    s_waitcnt vmcnt(5)
    v_swap_b32 v105, v108
    v_swap_b32 v107, v110
    ds_write_b128 v233, v[104:107] offset:6912
    ds_write_b128 v233, v[108:111] offset:8000
    ds_read_b64_tr_b16 v[196:197], v234 offset:4608
    ds_read_b64_tr_b16 v[198:199], v234 offset:6912
    ds_read_b64_tr_b16 v[200:201], v235 offset:4608
    ds_read_b64_tr_b16 v[202:203], v235 offset:6912
    ds_read_b64_tr_b16 v[204:205], v234 offset:4672
    ds_read_b64_tr_b16 v[206:207], v234 offset:6976
    ds_read_b64_tr_b16 v[208:209], v235 offset:4672
    ds_read_b64_tr_b16 v[210:211], v235 offset:6976
    s_waitcnt lgkmcnt(14)
    v_mfma_f32_16x16x32_bf16 v[228:231], v[180:183], v[212:215], v[228:231]
    v_mfma_f32_16x16x32_bf16 v[228:231], v[184:187], v[216:219], v[228:231]
    v_mfma_f32_16x16x32_bf16 v[228:231], v[188:191], v[220:223], v[228:231]
    s_waitcnt lgkmcnt(12)
    v_mfma_f32_16x16x32_bf16 v[228:231], v[192:195], v[224:227], v[228:231]
    s_waitcnt vmcnt(3)
    v_swap_b32 v113, v116
    v_swap_b32 v115, v118
    ds_write_b128 v233, v[112:115] offset:0
    ds_write_b128 v233, v[116:119] offset:1088
    s_waitcnt vmcnt(1)
    v_swap_b32 v121, v124
    v_swap_b32 v123, v126
    ds_write_b128 v233, v[120:123] offset:2304
    ds_write_b128 v233, v[124:127] offset:3392
    ds_read_b64_tr_b16 v[180:181], v234 offset:0
    ds_read_b64_tr_b16 v[182:183], v234 offset:2304
    ds_read_b64_tr_b16 v[184:185], v235 offset:0
    ds_read_b64_tr_b16 v[186:187], v235 offset:2304
    ds_read_b64_tr_b16 v[188:189], v234 offset:64
    ds_read_b64_tr_b16 v[190:191], v234 offset:2368
    ds_read_b64_tr_b16 v[192:193], v235 offset:64
    ds_read_b64_tr_b16 v[194:195], v235 offset:2368
    s_waitcnt lgkmcnt(14)
    v_mfma_f32_16x16x32_bf16 v[228:231], v[196:199], v[212:215], v[228:231]
L_ts2:
    s_cbranch_execz L_pc_spare
    v_mfma_f32_16x16x32_bf16 v[228:231], v[200:203], v[216:219], v[228:231]
    v_mfma_f32_16x16x32_bf16 v[228:231], v[204:207], v[220:223], v[228:231]
    s_waitcnt lgkmcnt(12)
    v_mfma_f32_16x16x32_bf16 v[228:231], v[208:211], v[224:227], v[228:231]
    s_waitcnt lgkmcnt(6)
    v_mfma_f32_16x16x32_bf16 v[228:231], v[180:183], v[212:215], v[228:231]
    s_waitcnt lgkmcnt(4)
    v_mfma_f32_16x16x32_bf16 v[228:231], v[184:187], v[216:219], v[228:231]
    s_waitcnt lgkmcnt(2)
    v_mfma_f32_16x16x32_bf16 v[228:231], v[188:191], v[220:223], v[228:231]
    s_waitcnt lgkmcnt(0)
    v_mfma_f32_16x16x32_bf16 v[228:231], v[192:195], v[224:227], v[228:231]
    s_nop 7
    ds_write_b128 v237, v[228:231]
    s_waitcnt lgkmcnt(0)
    s_barrier
    ds_read_b32 v16, v238 offset:0
    ds_read_b32 v17, v238 offset:1024
    ds_read_b32 v18, v238 offset:2048
    ds_read_b32 v19, v238 offset:3072
    s_waitcnt lgkmcnt(0)
    v_add_f32 v16, v16, v17
    v_add_f32 v18, v18, v19
    v_add_f32 v16, v16, v18
    buffer_store_dword v16, v239, s[68:71], 0 offen sc1
    v_lshrrev_b32 v239, 2, v0
    v_and_b32 v238, 3, v0
    v_lshlrev_b32 v238, 12, v238
    v_lshl_add_u32 v238, v239, 24, v238
    s_waitcnt vmcnt(0)
    s_barrier
    s_lshl_b32 s14, s77, 7
    s_add_u32 s14, s14, 0x20070
    buffer_store_dword v14, v238, s[32:35], s14 offen sc1
    s_add_u32 s52, s16, 7
    s_add_u32 s14, 3, 9
    s_min_u32 s39, s14, 26
    s_mov_b32 s55, 4
    s_mov_b32 s54, 3
    s_mov_b64 exec, 0
    s_branch L_tchk
L_tret3:
    s_mov_b64 exec, -1
    s_and_b32 s15, s2, 1
    s_lshl_b32 s15, s15, 3
    s_bfe_u32 s17, s2, 0x30003
    s_or_b32 s15, s15, s17
    s_bfe_u32 s14, s2, 0x20001
    s_lshl_b32 s14, s14, 2
    s_lshr_b32 s17, s2, 6
    s_or_b32 s14, s14, s17
    s_and_b32 s38, s16, 1
    s_lshr_b32 s17, s16, 1
    s_lshl_b32 s41, s15, 1
    s_add_u32 s41, s41, s17
    s_mul_i32 s42, s41, 100352
    s_mul_i32 s15, s38, 7168
    s_add_u32 s42, s42, s15
    s_add_u32 s42, s42, 0x1000000
    s_add_u32 s24, s12, s42
    s_addc_u32 s25, s13, 0
    s_mov_b32 s26, 93184
    s_mul_i32 s42, s41, 448
    s_add_u32 s42, s42, 0x1380000
    s_add_u32 s76, s12, s42
    s_addc_u32 s77, s13, 0
    s_mov_b32 s78, 448
    s_lshl_b32 s14, s14, 1
    s_add_u32 s14, s14, s38
    s_lshl_b32 s14, s14, 3
    s_lshr_b32 s15, s41, 2
    s_add_u32 s14, s14, s15
    s_mul_i32 s14, s14, 28672
    s_add_u32 s14, s14, 0x1800000
    s_add_u32 s20, s12, s14
    s_addc_u32 s21, s13, 0
    s_mov_b32 s22, 28672
    s_mov_b32 s23, 0x00020000
    s_mov_b32 s27, 0x00020000
    s_mov_b32 s79, 0x00020000
    s_mul_i32 s14, s41, 7
    v_bfe_u32 v250, v1, 4, 1
    v_mad_u32_u24 v250, v250, 6, s14
    v_lshrrev_b32 v250, 3, v250
    s_mul_i32 s14, s38, 14
    v_and_b32 v15, 15, v1
    v_min_u32 v15, 13, v15
    v_add_u32 v15, s14, v15
    v_lshl_add_u32 v15, v250, 5, v15
    s_and_b32 s14, s2, 3
    s_lshl_b32 s14, s14, 12
    s_add_u32 s14, s14, 0x20000
    v_lshl_add_u32 v15, v15, 2, s14
    v_mov_b32 v133, -16
    v_lshlrev_b32 v132, 4, v1
    buffer_load_dword v10, v15, s[32:35], 0 offen sc1
    s_waitcnt vmcnt(0)
    v_cmp_ne_u32 vcc, s3, v10
    s_cbranch_vccnz L_fu_w2
L_fu_w2b:
    s_branch L_fu_entry
L_pc_last:
L_code_end:
.section .rodata,"a"
.p2align 6
.amdhsa_kernel pc_kernel
  .amdhsa_next_free_vgpr 512
  .amdhsa_next_free_sgpr 102
  .amdhsa_accum_offset 256
  .amdhsa_group_segment_fixed_size 0
  .amdhsa_kernarg_size 104
  .amdhsa_user_sgpr_count 2
  .amdhsa_user_sgpr_kernarg_segment_ptr 1
  .amdhsa_system_sgpr_workgroup_id_x 1
.end_amdhsa_kernel
```
